```python
import torch

def _softmax(x, axis=-1):
    return torch.softmax(x, dim=axis)
def _gelu(x):
    return torch.nn.functional.gelu(x, approximate="tanh")
def _silu(x):
    return torch.nn.functional.silu(x)
def _sigmoid(x):
    return torch.sigmoid(x)
def _layernorm(x, axis=-1, eps=1e-5):
    m = x.mean(dim=axis, keepdim=True)
    v = x.var(dim=axis, keepdim=True, unbiased=False)
    return (x - m) / torch.sqrt(v + eps)
def _scatter_add(tgt, idx, src, axis=0):
    return tgt.clone().index_add_(axis, idx, src)
def _segment_sum(src, seg, n):
    out = torch.zeros((n,) + src.shape[1:], dtype=src.dtype)
    return out.index_add_(0, seg, src)
def _pad(x, pw):
    flat = tuple(v for pair in reversed(pw) for v in pair)
    return torch.nn.functional.pad(x, flat)

kernel_name = 'concat_heads__softmax_full_mha__sliding_block__prompt'

def setup_inputs():

    _w = (lambda a: (lambda t: t.to(torch.bfloat16) if t.is_floating_point() else t)(torch.as_tensor(a)))
    def _A_setup():
        B, S, D = 1, 2048, 512
        return {
            "x": _w((lambda *s: torch.randn(*s, dtype=torch.bfloat16) * 0.2)(B, S, D)),
            "wqkv": _w((lambda *s: torch.randn(*s, dtype=torch.bfloat16) * 0.4)(D, 3 * D)),
            "wo": _w((lambda *s: torch.randn(*s, dtype=torch.bfloat16) * 0.1)(D, D)),
        }
    _A_in = _A_setup()

    def _B_setup():
        B, S, D = 1, 2048, 512
        return {
            "x": _w((lambda *s: torch.randn(*s, dtype=torch.bfloat16) * 0.4)(B, S, D)),
            "wqkv": _w((lambda *s: torch.randn(*s, dtype=torch.bfloat16) * 0.4)(D, 3 * D)),
            "wo": _w((lambda *s: torch.randn(*s, dtype=torch.bfloat16) * 0.05)(D, D)),
        }
    _B_in = _B_setup()

    return {
        "A_x": _A_in["x"],
        "A_wqkv": _A_in["wqkv"],
        "A_wo": _A_in["wo"],
        "B_x": _B_in["x"],
        "B_wqkv": _B_in["wqkv"],
        "B_wo": _B_in["wo"],
    }

def reference(A_x, A_wqkv, A_wo, B_x, B_wqkv, B_wo):
    def _A_ref(x, wqkv, wo):
        B, S, D = x.shape
        H = 32; Dh = D // H
        qkv = (lambda x, *d: x.permute(*d))((x @ wqkv).reshape(B, S, 3, H, Dh), 2, 0, 3, 1, 4)
        q, k, v = qkv[0], qkv[1], qkv[2]
        scale = Dh ** -0.5
        scores = torch.einsum("bhqd,bhkd->bhqk", q, k) * scale
        p = _softmax(scores, axis=-1)
        o = torch.einsum("bhqk,bhkd->bhqd", p, v)
        return (lambda x, *d: x.permute(*d))(o, 0, 2, 1, 3).reshape(B, S, D) @ wo

    def _B_ref(x, wqkv, wo):
        B, S, D = x.shape
        H = 32; Dh = D // H; W = 256
        qkv = (lambda x, *d: x.permute(*d))((x @ wqkv).reshape(B, S, 3, H, Dh), 2, 0, 3, 1, 4)
        q, k, v = qkv[0], qkv[1], qkv[2]
        scores = torch.einsum("bhqd,bhkd->bhqk", q, k) * (Dh ** -0.5)
        idx = torch.arange(S)
        mask = (idx[:, None] - idx[None, :] >= 0) & (idx[:, None] - idx[None, :] < W)
        scores = torch.where(mask[None, None], scores, -1e9)
        p = _softmax(scores, axis=-1)
        o = torch.einsum("bhqk,bhkd->bhqd", p, v)
        return (lambda x, *d: x.permute(*d))(o, 0, 2, 1, 3).reshape(B, S, D) @ wo

    a = _A_ref(A_x, A_wqkv, A_wo)
    b = _B_ref(B_x, B_wqkv, B_wo)
    return torch.concatenate([a, b], axis=-1)
```

```asm
; @launch grid=(256,1,1) block=(512,1,1) lds=163840
.amdgcn_target "amdgcn-amd-amdhsa--gfx950"
.text
.globl concat_heads__softmax_full_mha__sliding_block__prompt_kernel
.p2align 8
.type concat_heads__softmax_full_mha__sliding_block__prompt_kernel,@function
concat_heads__softmax_full_mha__sliding_block__prompt_kernel:
  s_cmp_ge_u32 s2, 256
  s_cbranch_scc1 K_END
  s_load_dwordx16 s[32:47], s[0:1], 0
  s_load_dwordx2 s[48:49], s[0:1], 64
  v_and_b32 v1, 63, v0
  v_lshrrev_b32 v2, 6, v0
  s_and_b32 s4, s2, 7
  v_readfirstlane_b32 s3, v2
  s_lshr_b32 s5, s2, 3
  s_and_b32 s6, s4, 3
  s_lshl_b32 s6, s6, 3
  s_and_b32 s9, s5, 7
  s_add_u32 s6, s6, s9
  s_lshr_b32 s10, s5, 3
  s_lshl_b32 s7, s10, 1
  s_lshr_b32 s11, s4, 2
  s_xor_b32 s11, s11, 1
  s_add_u32 s7, s7, s11
  s_lshl_b32 s8, s10, 1
  s_add_u32 s8, s8, s9
  s_and_b32 s8, s8, 7
  s_cmp_lg_u32 s3, 1
  s_cbranch_scc1 CPF_DONE
  s_getpc_b64 s[50:51]
  s_and_b32 s50, s50, 0xffffff00
  s_lshl_b32 s52, s5, 10
  s_min_u32 s52, s52, K_CODE_END-concat_heads__softmax_full_mha__sliding_block__prompt_kernel-1024
  s_add_u32 s50, s50, s52
  s_addc_u32 s51, s51, 0
  v_lshlrev_b32 v3, 4, v1
  v_mov_b32 v5, s51
  v_add_co_u32 v4, vcc, s50, v3
  s_nop 1
  v_addc_co_u32 v5, vcc, 0, v5, vcc
  global_load_dwordx4 v[240:243], v[4:5], off
CPF_DONE:
  v_lshlrev_b32 v17, 4, v1
  v_bfe_u32 v18, v1, 4, 1
  v_lshlrev_b32 v18, 17, v18
  v_lshrrev_b32 v19, 5, v1
  v_lshlrev_b32 v19, 8, v19
  v_add_u32 v18, v18, v19
  v_and_b32 v19, 15, v1
  v_lshlrev_b32 v19, 4, v19
  v_add_u32 v18, v18, v19
  v_add_u32 v18, 0x400, v18
  s_waitcnt lgkmcnt(0)
  s_mov_b32 s12, s32
  s_and_b32 s13, s33, 0xffff
  s_mov_b32 s14, 0x200000
  s_mov_b32 s15, 0x00020000
  s_mov_b32 s16, s34
  s_and_b32 s17, s35, 0xffff
  s_mov_b32 s18, 0x180000
  s_mov_b32 s19, 0x00020000
  s_mov_b32 s20, s48
  s_and_b32 s21, s49, 0xffff
  s_mov_b32 s22, 0x1000000
  s_mov_b32 s23, 0x00020000
  s_mov_b32 s24, s38
  s_and_b32 s25, s39, 0xffff
  s_mov_b32 s26, 0x200000
  s_mov_b32 s27, 0x00020000
  s_mov_b32 s28, s40
  s_and_b32 s29, s41, 0xffff
  s_mov_b32 s30, 0x180000
  s_mov_b32 s31, 0x00020000
  s_mov_b32 s80, s36
  s_and_b32 s81, s37, 0xffff
  s_mov_b32 s82, 0x80000
  s_mov_b32 s83, 0x00020000
  s_mov_b32 s84, s42
  s_and_b32 s85, s43, 0xffff
  s_mov_b32 s86, 0x80000
  s_mov_b32 s87, 0x00020000
  s_mov_b32 s88, s44
  s_and_b32 s89, s45, 0xffff
  s_mov_b32 s90, 0x400000
  s_mov_b32 s91, 0x00020000
  s_cmp_ge_u32 s3, 4
  s_cbranch_scc1 P1_LOADER
  s_and_b32 s50, s3, 1
  s_lshr_b32 s51, s3, 1
  s_lshl_b32 s52, s51, 6
  v_and_b32 v2, 31, v1
  s_lshl_b32 s53, s50, 5
  v_add_u32 v2, s53, v2
  v_bfe_u32 v3, v2, 1, 3
  v_lshlrev_b32 v2, 7, v2
  v_lshrrev_b32 v8, 5, v1
  v_add_u32 v9, 0, v8
  v_xor_b32 v9, v9, v3
  v_lshlrev_b32 v9, 4, v9
  v_add_u32 v4, v2, v9
  v_add_u32 v9, 2, v8
  v_xor_b32 v9, v9, v3
  v_lshlrev_b32 v9, 4, v9
  v_add_u32 v5, v2, v9
  v_add_u32 v9, 4, v8
  v_xor_b32 v9, v9, v3
  v_lshlrev_b32 v9, 4, v9
  v_add_u32 v6, v2, v9
  v_add_u32 v9, 6, v8
  v_xor_b32 v9, v9, v3
  v_lshlrev_b32 v9, 4, v9
  v_add_u32 v7, v2, v9
  v_and_b32 v8, 1, v1
  v_lshlrev_b32 v8, 1, v8
  v_bfe_u32 v9, v1, 1, 1
  v_or_b32 v8, v8, v9
  v_bfe_u32 v9, v1, 4, 1
  v_lshlrev_b32 v9, 2, v9
  v_or_b32 v8, v8, v9
  v_lshlrev_b32 v8, 3, v8
  v_bfe_u32 v9, v1, 3, 1
  v_lshlrev_b32 v9, 6, v9
  v_xor_b32 v8, v8, v9
  v_bfe_u32 v9, v1, 2, 2
  v_lshlrev_b32 v9, 7, v9
  v_add_u32 v8, v8, v9
  v_lshrrev_b32 v9, 5, v1
  v_lshlrev_b32 v9, 10, v9
  v_add_u32 v10, v8, v9
  v_xor_b32 v10, s52, v10
  v_add_u32 v10, 0x2000, v10
  v_mov_b32 v30, v4
  v_mov_b32 v31, v5
  v_mov_b32 v29, v6
  v_and_b32 v4, 31, v1
  v_lshrrev_b32 v5, 5, v1
  v_lshlrev_b32 v5, 2, v5
  v_sub_u32 v4, v4, v5
  v_mov_b32 v6, 0xff800000
  v_subrev_u32 v64, 0, v4
  v_ashrrev_i32 v64, 31, v64
  v_and_b32 v112, v64, v6
  v_subrev_u32 v65, 1, v4
  v_ashrrev_i32 v65, 31, v65
  v_and_b32 v113, v65, v6
  v_subrev_u32 v66, 2, v4
  v_ashrrev_i32 v66, 31, v66
  v_and_b32 v114, v66, v6
  v_subrev_u32 v67, 3, v4
  v_ashrrev_i32 v67, 31, v67
  v_and_b32 v115, v67, v6
  v_subrev_u32 v68, 8, v4
  v_ashrrev_i32 v68, 31, v68
  v_and_b32 v116, v68, v6
  v_subrev_u32 v69, 9, v4
  v_ashrrev_i32 v69, 31, v69
  v_and_b32 v117, v69, v6
  v_subrev_u32 v70, 10, v4
  v_ashrrev_i32 v70, 31, v70
  v_and_b32 v118, v70, v6
  v_subrev_u32 v71, 11, v4
  v_ashrrev_i32 v71, 31, v71
  v_and_b32 v119, v71, v6
  v_subrev_u32 v72, 16, v4
  v_ashrrev_i32 v72, 31, v72
  v_and_b32 v120, v72, v6
  v_subrev_u32 v73, 17, v4
  v_ashrrev_i32 v73, 31, v73
  v_and_b32 v121, v73, v6
  v_subrev_u32 v74, 18, v4
  v_ashrrev_i32 v74, 31, v74
  v_and_b32 v122, v74, v6
  v_subrev_u32 v75, 19, v4
  v_ashrrev_i32 v75, 31, v75
  v_and_b32 v123, v75, v6
  v_subrev_u32 v76, 24, v4
  v_ashrrev_i32 v76, 31, v76
  v_and_b32 v124, v76, v6
  v_subrev_u32 v77, 25, v4
  v_ashrrev_i32 v77, 31, v77
  v_and_b32 v125, v77, v6
  v_subrev_u32 v78, 26, v4
  v_ashrrev_i32 v78, 31, v78
  v_and_b32 v126, v78, v6
  v_subrev_u32 v79, 27, v4
  v_ashrrev_i32 v79, 31, v79
  v_and_b32 v127, v79, v6
  v_mov_b32 v5, 0xffff0000
  v_bfi_b32 v104, v5, v65, v64
  v_not_b32 v96, v104
  v_bfi_b32 v105, v5, v67, v66
  v_not_b32 v97, v105
  v_bfi_b32 v106, v5, v69, v68
  v_not_b32 v98, v106
  v_bfi_b32 v107, v5, v71, v70
  v_not_b32 v99, v107
  v_bfi_b32 v108, v5, v73, v72
  v_not_b32 v100, v108
  v_bfi_b32 v109, v5, v75, v74
  v_not_b32 v101, v109
  v_bfi_b32 v110, v5, v77, v76
  v_not_b32 v102, v110
  v_bfi_b32 v111, v5, v79, v78
  v_not_b32 v103, v111
  v_mov_b32 v4, v30
  v_mov_b32 v5, v31
  v_mov_b32 v6, v29
  v_mov_b32 v32, 0
  v_mov_b32 v33, 0
  v_mov_b32 v34, 0
  v_mov_b32 v35, 0
  v_mov_b32 v36, 0
  v_mov_b32 v37, 0
  v_mov_b32 v38, 0
  v_mov_b32 v39, 0
  v_mov_b32 v40, 0
  v_mov_b32 v41, 0
  v_mov_b32 v42, 0
  v_mov_b32 v43, 0
  v_mov_b32 v44, 0
  v_mov_b32 v45, 0
  v_mov_b32 v46, 0
  v_mov_b32 v47, 0
  v_mov_b32 v48, 0
  v_mov_b32 v49, 0
  v_mov_b32 v50, 0
  v_mov_b32 v51, 0
  v_mov_b32 v52, 0
  v_mov_b32 v53, 0
  v_mov_b32 v54, 0
  v_mov_b32 v55, 0
  v_mov_b32 v56, 0
  v_mov_b32 v57, 0
  v_mov_b32 v58, 0
  v_mov_b32 v59, 0
  v_mov_b32 v60, 0
  v_mov_b32 v61, 0
  v_mov_b32 v62, 0
  v_mov_b32 v63, 0
  v_mov_b32 v64, 0
  v_mov_b32 v65, 0
  v_mov_b32 v66, 0
  v_mov_b32 v67, 0
  v_mov_b32 v68, 0
  v_mov_b32 v69, 0
  v_mov_b32 v70, 0
  v_mov_b32 v71, 0
  v_mov_b32 v72, 0
  v_mov_b32 v73, 0
  v_mov_b32 v74, 0
  v_mov_b32 v75, 0
  v_mov_b32 v76, 0
  v_mov_b32 v77, 0
  v_mov_b32 v78, 0
  v_mov_b32 v79, 0
  v_mov_b32 v80, 0
  v_mov_b32 v81, 0
  v_mov_b32 v82, 0
  v_mov_b32 v83, 0
  v_mov_b32 v84, 0
  v_mov_b32 v85, 0
  v_mov_b32 v86, 0
  v_mov_b32 v87, 0
  v_mov_b32 v88, 0
  v_mov_b32 v89, 0
  v_mov_b32 v90, 0
  v_mov_b32 v91, 0
  v_mov_b32 v92, 0
  v_mov_b32 v93, 0
  v_mov_b32 v94, 0
  v_mov_b32 v95, 0
  v_mov_b32 v192, 0
  v_mov_b32 v193, 0
  v_mov_b32 v194, 0
  v_mov_b32 v195, 0
  v_mov_b32 v196, 0
  v_mov_b32 v197, 0
  v_mov_b32 v198, 0
  v_mov_b32 v199, 0
  v_mov_b32 v200, 0
  v_mov_b32 v201, 0
  v_mov_b32 v202, 0
  v_mov_b32 v203, 0
  v_mov_b32 v204, 0
  v_mov_b32 v205, 0
  v_mov_b32 v206, 0
  v_mov_b32 v207, 0
  v_mov_b32 v208, 0
  v_mov_b32 v209, 0
  v_mov_b32 v210, 0
  v_mov_b32 v211, 0
  v_mov_b32 v212, 0
  v_mov_b32 v213, 0
  v_mov_b32 v214, 0
  v_mov_b32 v215, 0
  v_mov_b32 v216, 0
  v_mov_b32 v217, 0
  v_mov_b32 v218, 0
  v_mov_b32 v219, 0
  v_mov_b32 v220, 0
  v_mov_b32 v221, 0
  v_mov_b32 v222, 0
  v_mov_b32 v223, 0
  s_lshl_b32 s53, s7, 2
  s_lshl_b32 s54, s51, 1
  s_add_u32 s53, s53, s54
  s_lshl_b32 s53, s53, 6
  s_lshl_b32 s54, s6, 1
  s_add_u32 s53, s53, s54
  s_add_u32 s53, s53, s50
  s_lshl_b32 s54, s53, 10
  s_lshl_b32 s55, s53, 11
  s_add_u32 s55, s55, 0x400000
  s_mov_b32 s56, 0x3eb8aa3b
  s_cmp_lg_u32 s3, 0
  s_cbranch_scc1 TOK0_SKIP
  v_mov_b32 v22, 0
  s_mov_b64 exec, 1
  s_cmp_lg_u32 s2, 0
  s_cbranch_scc1 TOK0_GET
  s_memrealtime s[62:63]
  s_waitcnt lgkmcnt(0)
  s_or_b32 s62, s62, 1
  v_mov_b32 v20, s62
  v_mov_b32 v21, s63
  global_store_dwordx2 v22, v[20:21], s[46:47] sc1
  s_branch TOK0_FIN
TOK0_GET:
  s_mov_b32 s57, 0x40000
TOK0_POLL:
  global_load_dwordx2 v[20:21], v22, s[46:47] sc1
  s_waitcnt vmcnt(0)
  v_readfirstlane_b32 s62, v20
  v_readfirstlane_b32 s63, v21
  s_nop 3
  s_cmp_lg_u32 s62, 0
  s_cbranch_scc1 TOK0_FIN
  s_sleep 8
  s_sub_u32 s57, s57, 1
  s_cmp_lg_u32 s57, 0
  s_cbranch_scc1 TOK0_POLL
TOK0_FIN:
  s_mov_b64 exec, -1
TOK0_SKIP:
  s_barrier
  ds_read_b128 v[128:131], v4 offset:0
  ds_read_b64_tr_b16 v[132:133], v10 offset:0
  ds_read_b64_tr_b16 v[134:135], v10 offset:512
  ds_read_b64_tr_b16 v[136:137], v10 offset:8192
  ds_read_b64_tr_b16 v[138:139], v10 offset:8704
  ds_read_b64_tr_b16 v[140:141], v10 offset:16384
  ds_read_b64_tr_b16 v[142:143], v10 offset:16896
  ds_read_b128 v[144:147], v5 offset:0
  ds_read_b64_tr_b16 v[148:149], v10 offset:2048
  ds_read_b64_tr_b16 v[150:151], v10 offset:2560
  ds_read_b64_tr_b16 v[152:153], v10 offset:10240
  ds_read_b64_tr_b16 v[154:155], v10 offset:10752
  ds_read_b64_tr_b16 v[156:157], v10 offset:18432
  ds_read_b64_tr_b16 v[158:159], v10 offset:18944
  s_mov_b32 s57, 0
.p2align 6
P1A_LOOP:
  s_waitcnt lgkmcnt(7)
  v_mfma_f32_32x32x16_bf16 v[32:47], v[132:135], v[128:131], v[32:47]
  ds_read_b128 v[160:163], v6 offset:0
  ds_read_b64_tr_b16 v[164:165], v10 offset:4096
  ds_read_b64_tr_b16 v[166:167], v10 offset:4608
  v_mfma_f32_32x32x16_bf16 v[48:63], v[136:139], v[128:131], v[48:63]
  ds_read_b64_tr_b16 v[168:169], v10 offset:12288
  ds_read_b64_tr_b16 v[170:171], v10 offset:12800
  v_mfma_f32_32x32x16_bf16 v[64:79], v[128:131], v[140:143], v[64:79]
  ds_read_b64_tr_b16 v[172:173], v10 offset:20480
  ds_read_b64_tr_b16 v[174:175], v10 offset:20992
  s_waitcnt lgkmcnt(7)
  v_mfma_f32_32x32x16_bf16 v[32:47], v[148:151], v[144:147], v[32:47]
  ds_read_b128 v[176:179], v7 offset:0
  ds_read_b64_tr_b16 v[180:181], v10 offset:6144
  ds_read_b64_tr_b16 v[182:183], v10 offset:6656
  v_mfma_f32_32x32x16_bf16 v[48:63], v[152:155], v[144:147], v[48:63]
  ds_read_b64_tr_b16 v[184:185], v10 offset:14336
  ds_read_b64_tr_b16 v[186:187], v10 offset:14848
  v_mfma_f32_32x32x16_bf16 v[64:79], v[144:147], v[156:159], v[64:79]
  ds_read_b64_tr_b16 v[188:189], v10 offset:22528
  ds_read_b64_tr_b16 v[190:191], v10 offset:23040
  s_waitcnt lgkmcnt(0)
  s_barrier
  v_mfma_f32_32x32x16_bf16 v[32:47], v[164:167], v[160:163], v[32:47]
  ds_read_b128 v[128:131], v4 offset:32768
  ds_read_b64_tr_b16 v[132:133], v10 offset:32768
  ds_read_b64_tr_b16 v[134:135], v10 offset:33280
  v_mfma_f32_32x32x16_bf16 v[48:63], v[168:171], v[160:163], v[48:63]
  ds_read_b64_tr_b16 v[136:137], v10 offset:40960
  ds_read_b64_tr_b16 v[138:139], v10 offset:41472
  v_mfma_f32_32x32x16_bf16 v[64:79], v[160:163], v[172:175], v[64:79]
  ds_read_b64_tr_b16 v[140:141], v10 offset:49152
  ds_read_b64_tr_b16 v[142:143], v10 offset:49664
  s_waitcnt lgkmcnt(7)
  v_mfma_f32_32x32x16_bf16 v[32:47], v[180:183], v[176:179], v[32:47]
  ds_read_b128 v[144:147], v5 offset:32768
  ds_read_b64_tr_b16 v[148:149], v10 offset:34816
  ds_read_b64_tr_b16 v[150:151], v10 offset:35328
  v_mfma_f32_32x32x16_bf16 v[48:63], v[184:187], v[176:179], v[48:63]
  ds_read_b64_tr_b16 v[152:153], v10 offset:43008
  ds_read_b64_tr_b16 v[154:155], v10 offset:43520
  v_mfma_f32_32x32x16_bf16 v[64:79], v[176:179], v[188:191], v[64:79]
  ds_read_b64_tr_b16 v[156:157], v10 offset:51200
  ds_read_b64_tr_b16 v[158:159], v10 offset:51712
  s_waitcnt lgkmcnt(7)
  v_mfma_f32_32x32x16_bf16 v[32:47], v[132:135], v[128:131], v[32:47]
  ds_read_b128 v[160:163], v6 offset:32768
  ds_read_b64_tr_b16 v[164:165], v10 offset:36864
  ds_read_b64_tr_b16 v[166:167], v10 offset:37376
  v_mfma_f32_32x32x16_bf16 v[48:63], v[136:139], v[128:131], v[48:63]
  ds_read_b64_tr_b16 v[168:169], v10 offset:45056
  ds_read_b64_tr_b16 v[170:171], v10 offset:45568
  v_mfma_f32_32x32x16_bf16 v[64:79], v[128:131], v[140:143], v[64:79]
  ds_read_b64_tr_b16 v[172:173], v10 offset:53248
  ds_read_b64_tr_b16 v[174:175], v10 offset:53760
  s_waitcnt lgkmcnt(7)
  v_mfma_f32_32x32x16_bf16 v[32:47], v[148:151], v[144:147], v[32:47]
  ds_read_b128 v[176:179], v7 offset:32768
  ds_read_b64_tr_b16 v[180:181], v10 offset:38912
  ds_read_b64_tr_b16 v[182:183], v10 offset:39424
  v_mfma_f32_32x32x16_bf16 v[48:63], v[152:155], v[144:147], v[48:63]
  ds_read_b64_tr_b16 v[184:185], v10 offset:47104
  ds_read_b64_tr_b16 v[186:187], v10 offset:47616
  v_mfma_f32_32x32x16_bf16 v[64:79], v[144:147], v[156:159], v[64:79]
  ds_read_b64_tr_b16 v[188:189], v10 offset:55296
  ds_read_b64_tr_b16 v[190:191], v10 offset:55808
  s_waitcnt lgkmcnt(0)
  s_barrier
  v_xor_b32 v4, 0x10000, v4
  v_xor_b32 v5, 0x10000, v5
  v_xor_b32 v6, 0x10000, v6
  v_xor_b32 v7, 0x10000, v7
  v_xor_b32 v10, 0x10000, v10
  v_mfma_f32_32x32x16_bf16 v[32:47], v[164:167], v[160:163], v[32:47]
  ds_read_b128 v[128:131], v4 offset:0
  ds_read_b64_tr_b16 v[132:133], v10 offset:0
  ds_read_b64_tr_b16 v[134:135], v10 offset:512
  v_mfma_f32_32x32x16_bf16 v[48:63], v[168:171], v[160:163], v[48:63]
  ds_read_b64_tr_b16 v[136:137], v10 offset:8192
  ds_read_b64_tr_b16 v[138:139], v10 offset:8704
  v_mfma_f32_32x32x16_bf16 v[64:79], v[160:163], v[172:175], v[64:79]
  ds_read_b64_tr_b16 v[140:141], v10 offset:16384
  ds_read_b64_tr_b16 v[142:143], v10 offset:16896
  s_waitcnt lgkmcnt(7)
  v_mfma_f32_32x32x16_bf16 v[32:47], v[180:183], v[176:179], v[32:47]
  ds_read_b128 v[144:147], v5 offset:0
  ds_read_b64_tr_b16 v[148:149], v10 offset:2048
  ds_read_b64_tr_b16 v[150:151], v10 offset:2560
  v_mfma_f32_32x32x16_bf16 v[48:63], v[184:187], v[176:179], v[48:63]
  ds_read_b64_tr_b16 v[152:153], v10 offset:10240
  ds_read_b64_tr_b16 v[154:155], v10 offset:10752
  v_mfma_f32_32x32x16_bf16 v[64:79], v[176:179], v[188:191], v[64:79]
  ds_read_b64_tr_b16 v[156:157], v10 offset:18432
  ds_read_b64_tr_b16 v[158:159], v10 offset:18944
  s_add_u32 s57, s57, 1
  s_cmp_lt_u32 s57, 4
  s_cbranch_scc1 P1A_LOOP
  s_waitcnt lgkmcnt(7)
  v_mfma_f32_32x32x16_bf16 v[80:95], v[132:135], v[128:131], v[80:95]
  ds_read_b128 v[160:163], v6 offset:0
  ds_read_b64_tr_b16 v[164:165], v10 offset:4096
  ds_read_b64_tr_b16 v[166:167], v10 offset:4608
  v_mfma_f32_32x32x16_bf16 v[192:207], v[136:139], v[128:131], v[192:207]
  ds_read_b64_tr_b16 v[168:169], v10 offset:12288
  ds_read_b64_tr_b16 v[170:171], v10 offset:12800
  v_mfma_f32_32x32x16_bf16 v[208:223], v[128:131], v[140:143], v[208:223]
  ds_read_b64_tr_b16 v[172:173], v10 offset:20480
  ds_read_b64_tr_b16 v[174:175], v10 offset:20992
  s_waitcnt lgkmcnt(7)
  v_mfma_f32_32x32x16_bf16 v[80:95], v[148:151], v[144:147], v[80:95]
  ds_read_b128 v[176:179], v7 offset:0
  ds_read_b64_tr_b16 v[180:181], v10 offset:6144
  ds_read_b64_tr_b16 v[182:183], v10 offset:6656
  v_mul_f32 v32, s56, v32
  v_mul_f32 v33, s56, v33
  v_mul_f32 v34, s56, v34
  v_mul_f32 v35, s56, v35
  v_mfma_f32_32x32x16_bf16 v[192:207], v[152:155], v[144:147], v[192:207]
  ds_read_b64_tr_b16 v[184:185], v10 offset:14336
  ds_read_b64_tr_b16 v[186:187], v10 offset:14848
  v_mul_f32 v36, s56, v36
  v_mul_f32 v37, s56, v37
  v_mul_f32 v38, s56, v38
  v_mul_f32 v39, s56, v39
  v_mfma_f32_32x32x16_bf16 v[208:223], v[144:147], v[156:159], v[208:223]
  ds_read_b64_tr_b16 v[188:189], v10 offset:22528
  ds_read_b64_tr_b16 v[190:191], v10 offset:23040
  v_mul_f32 v40, s56, v40
  v_mul_f32 v41, s56, v41
  v_mul_f32 v42, s56, v42
  v_mul_f32 v43, s56, v43
  s_waitcnt lgkmcnt(0)
  s_barrier
  v_mfma_f32_32x32x16_bf16 v[80:95], v[164:167], v[160:163], v[80:95]
  ds_read_b128 v[128:131], v4 offset:32768
  ds_read_b64_tr_b16 v[132:133], v10 offset:32768
  ds_read_b64_tr_b16 v[134:135], v10 offset:33280
  v_mul_f32 v44, s56, v44
  v_mul_f32 v45, s56, v45
  v_mul_f32 v46, s56, v46
  v_mul_f32 v47, s56, v47
  v_mfma_f32_32x32x16_bf16 v[192:207], v[168:171], v[160:163], v[192:207]
  ds_read_b64_tr_b16 v[136:137], v10 offset:40960
  ds_read_b64_tr_b16 v[138:139], v10 offset:41472
  v_cvt_pk_bf16_f32 v24, v32, v33
  v_cvt_pk_bf16_f32 v25, v34, v35
  v_cvt_pk_bf16_f32 v26, v36, v37
  v_cvt_pk_bf16_f32 v27, v38, v39
  v_mfma_f32_32x32x16_bf16 v[208:223], v[160:163], v[172:175], v[208:223]
  ds_read_b64_tr_b16 v[140:141], v10 offset:49152
  ds_read_b64_tr_b16 v[142:143], v10 offset:49664
  v_cvt_pk_bf16_f32 v28, v40, v41
  v_cvt_pk_bf16_f32 v29, v42, v43
  v_cvt_pk_bf16_f32 v30, v44, v45
  v_cvt_pk_bf16_f32 v31, v46, v47
  s_waitcnt lgkmcnt(7)
  v_mfma_f32_32x32x16_bf16 v[80:95], v[180:183], v[176:179], v[80:95]
  ds_read_b128 v[144:147], v5 offset:32768
  ds_read_b64_tr_b16 v[148:149], v10 offset:34816
  ds_read_b64_tr_b16 v[150:151], v10 offset:35328
  s_add_u32 s58, s54, 0
  buffer_store_dwordx4 v[24:27], v17, s[20:23], s58 offen sc1
  s_add_u32 s58, s54, 65536
  buffer_store_dwordx4 v[28:31], v17, s[20:23], s58 offen sc1
  v_mfma_f32_32x32x16_bf16 v[192:207], v[184:187], v[176:179], v[192:207]
  ds_read_b64_tr_b16 v[152:153], v10 offset:43008
  ds_read_b64_tr_b16 v[154:155], v10 offset:43520
  s_nop 0
  v_cvt_pk_bf16_f32 v24, v48, v49
  v_cvt_pk_bf16_f32 v25, v50, v51
  v_cvt_pk_bf16_f32 v26, v52, v53
  v_mfma_f32_32x32x16_bf16 v[208:223], v[176:179], v[188:191], v[208:223]
  ds_read_b64_tr_b16 v[156:157], v10 offset:51200
  ds_read_b64_tr_b16 v[158:159], v10 offset:51712
  v_cvt_pk_bf16_f32 v27, v54, v55
  v_cvt_pk_bf16_f32 v28, v56, v57
  v_cvt_pk_bf16_f32 v29, v58, v59
  v_cvt_pk_bf16_f32 v30, v60, v61
  s_waitcnt lgkmcnt(7)
  v_mfma_f32_32x32x16_bf16 v[80:95], v[132:135], v[128:131], v[80:95]
  ds_read_b128 v[160:163], v6 offset:32768
  ds_read_b64_tr_b16 v[164:165], v10 offset:36864
  ds_read_b64_tr_b16 v[166:167], v10 offset:37376
  v_cvt_pk_bf16_f32 v31, v62, v63
  s_add_u32 s58, s55, 0
  buffer_store_dwordx4 v[24:27], v17, s[20:23], s58 offen sc1
  s_add_u32 s58, s55, 131072
  v_mfma_f32_32x32x16_bf16 v[192:207], v[136:139], v[128:131], v[192:207]
  ds_read_b64_tr_b16 v[168:169], v10 offset:45056
  ds_read_b64_tr_b16 v[170:171], v10 offset:45568
  buffer_store_dwordx4 v[28:31], v17, s[20:23], s58 offen sc1
  s_nop 0
  v_cvt_pk_bf16_f32 v24, v64, v65
  v_cvt_pk_bf16_f32 v25, v66, v67
  v_mfma_f32_32x32x16_bf16 v[208:223], v[128:131], v[140:143], v[208:223]
  ds_read_b64_tr_b16 v[172:173], v10 offset:53248
  ds_read_b64_tr_b16 v[174:175], v10 offset:53760
  v_cvt_pk_bf16_f32 v26, v68, v69
  v_cvt_pk_bf16_f32 v27, v70, v71
  v_cvt_pk_bf16_f32 v28, v72, v73
  v_cvt_pk_bf16_f32 v29, v74, v75
  s_waitcnt lgkmcnt(7)
  v_mfma_f32_32x32x16_bf16 v[80:95], v[148:151], v[144:147], v[80:95]
  ds_read_b128 v[176:179], v7 offset:32768
  ds_read_b64_tr_b16 v[180:181], v10 offset:38912
  ds_read_b64_tr_b16 v[182:183], v10 offset:39424
  v_cvt_pk_bf16_f32 v30, v76, v77
  v_cvt_pk_bf16_f32 v31, v78, v79
  s_add_u32 s58, s55, 0
  buffer_store_dwordx4 v[24:27], v18, s[20:23], s58 offen sc1
  v_mfma_f32_32x32x16_bf16 v[192:207], v[152:155], v[144:147], v[192:207]
  ds_read_b64_tr_b16 v[184:185], v10 offset:47104
  ds_read_b64_tr_b16 v[186:187], v10 offset:47616
  buffer_store_dwordx4 v[28:31], v18, s[20:23], s58 offen offset:512 sc1
  v_mfma_f32_32x32x16_bf16 v[208:223], v[144:147], v[156:159], v[208:223]
  ds_read_b64_tr_b16 v[188:189], v10 offset:55296
  ds_read_b64_tr_b16 v[190:191], v10 offset:55808
  s_waitcnt lgkmcnt(0)
  s_barrier
  v_xor_b32 v4, 0x10000, v4
  v_xor_b32 v5, 0x10000, v5
  v_xor_b32 v6, 0x10000, v6
  v_xor_b32 v7, 0x10000, v7
  v_xor_b32 v10, 0x10000, v10
  v_mfma_f32_32x32x16_bf16 v[80:95], v[164:167], v[160:163], v[80:95]
  ds_read_b128 v[128:131], v4 offset:0
  ds_read_b64_tr_b16 v[132:133], v10 offset:0
  ds_read_b64_tr_b16 v[134:135], v10 offset:512
  v_mfma_f32_32x32x16_bf16 v[192:207], v[168:171], v[160:163], v[192:207]
  ds_read_b64_tr_b16 v[136:137], v10 offset:8192
  ds_read_b64_tr_b16 v[138:139], v10 offset:8704
  v_mfma_f32_32x32x16_bf16 v[208:223], v[160:163], v[172:175], v[208:223]
  ds_read_b64_tr_b16 v[140:141], v10 offset:16384
  ds_read_b64_tr_b16 v[142:143], v10 offset:16896
  s_waitcnt lgkmcnt(7)
  v_mfma_f32_32x32x16_bf16 v[80:95], v[180:183], v[176:179], v[80:95]
  ds_read_b128 v[144:147], v5 offset:0
  ds_read_b64_tr_b16 v[148:149], v10 offset:2048
  ds_read_b64_tr_b16 v[150:151], v10 offset:2560
  v_mfma_f32_32x32x16_bf16 v[192:207], v[184:187], v[176:179], v[192:207]
  ds_read_b64_tr_b16 v[152:153], v10 offset:10240
  ds_read_b64_tr_b16 v[154:155], v10 offset:10752
  v_mfma_f32_32x32x16_bf16 v[208:223], v[176:179], v[188:191], v[208:223]
  ds_read_b64_tr_b16 v[156:157], v10 offset:18432
  ds_read_b64_tr_b16 v[158:159], v10 offset:18944
  s_mov_b32 s57, 0
.p2align 6
P1B_LOOP:
  s_waitcnt lgkmcnt(7)
  v_mfma_f32_32x32x16_bf16 v[80:95], v[132:135], v[128:131], v[80:95]
  ds_read_b128 v[160:163], v6 offset:0
  ds_read_b64_tr_b16 v[164:165], v10 offset:4096
  ds_read_b64_tr_b16 v[166:167], v10 offset:4608
  v_mfma_f32_32x32x16_bf16 v[192:207], v[136:139], v[128:131], v[192:207]
  ds_read_b64_tr_b16 v[168:169], v10 offset:12288
  ds_read_b64_tr_b16 v[170:171], v10 offset:12800
  v_mfma_f32_32x32x16_bf16 v[208:223], v[128:131], v[140:143], v[208:223]
  ds_read_b64_tr_b16 v[172:173], v10 offset:20480
  ds_read_b64_tr_b16 v[174:175], v10 offset:20992
  s_waitcnt lgkmcnt(7)
  v_mfma_f32_32x32x16_bf16 v[80:95], v[148:151], v[144:147], v[80:95]
  ds_read_b128 v[176:179], v7 offset:0
  ds_read_b64_tr_b16 v[180:181], v10 offset:6144
  ds_read_b64_tr_b16 v[182:183], v10 offset:6656
  v_mfma_f32_32x32x16_bf16 v[192:207], v[152:155], v[144:147], v[192:207]
  ds_read_b64_tr_b16 v[184:185], v10 offset:14336
  ds_read_b64_tr_b16 v[186:187], v10 offset:14848
  v_mfma_f32_32x32x16_bf16 v[208:223], v[144:147], v[156:159], v[208:223]
  ds_read_b64_tr_b16 v[188:189], v10 offset:22528
  ds_read_b64_tr_b16 v[190:191], v10 offset:23040
  s_waitcnt lgkmcnt(0)
  s_cmp_eq_u32 s57, 0
  s_cbranch_scc1 P1_ABAR
  s_cmp_eq_u32 s57, 2
  s_cbranch_scc1 P1_AB_E
  s_barrier
P1_AB_E:
  v_mfma_f32_32x32x16_bf16 v[80:95], v[164:167], v[160:163], v[80:95]
  ds_read_b128 v[128:131], v4 offset:32768
  ds_read_b64_tr_b16 v[132:133], v10 offset:32768
  ds_read_b64_tr_b16 v[134:135], v10 offset:33280
  v_mfma_f32_32x32x16_bf16 v[192:207], v[168:171], v[160:163], v[192:207]
  ds_read_b64_tr_b16 v[136:137], v10 offset:40960
  ds_read_b64_tr_b16 v[138:139], v10 offset:41472
  v_mfma_f32_32x32x16_bf16 v[208:223], v[160:163], v[172:175], v[208:223]
  ds_read_b64_tr_b16 v[140:141], v10 offset:49152
  ds_read_b64_tr_b16 v[142:143], v10 offset:49664
  s_waitcnt lgkmcnt(7)
  v_mfma_f32_32x32x16_bf16 v[80:95], v[180:183], v[176:179], v[80:95]
  ds_read_b128 v[144:147], v5 offset:32768
  ds_read_b64_tr_b16 v[148:149], v10 offset:34816
  ds_read_b64_tr_b16 v[150:151], v10 offset:35328
  v_mfma_f32_32x32x16_bf16 v[192:207], v[184:187], v[176:179], v[192:207]
  ds_read_b64_tr_b16 v[152:153], v10 offset:43008
  ds_read_b64_tr_b16 v[154:155], v10 offset:43520
  v_mfma_f32_32x32x16_bf16 v[208:223], v[176:179], v[188:191], v[208:223]
  ds_read_b64_tr_b16 v[156:157], v10 offset:51200
  ds_read_b64_tr_b16 v[158:159], v10 offset:51712
  s_waitcnt lgkmcnt(7)
  v_mfma_f32_32x32x16_bf16 v[80:95], v[132:135], v[128:131], v[80:95]
  ds_read_b128 v[160:163], v6 offset:32768
  ds_read_b64_tr_b16 v[164:165], v10 offset:36864
  ds_read_b64_tr_b16 v[166:167], v10 offset:37376
  v_mfma_f32_32x32x16_bf16 v[192:207], v[136:139], v[128:131], v[192:207]
  ds_read_b64_tr_b16 v[168:169], v10 offset:45056
  ds_read_b64_tr_b16 v[170:171], v10 offset:45568
  v_mfma_f32_32x32x16_bf16 v[208:223], v[128:131], v[140:143], v[208:223]
  ds_read_b64_tr_b16 v[172:173], v10 offset:53248
  ds_read_b64_tr_b16 v[174:175], v10 offset:53760
  s_waitcnt lgkmcnt(7)
  v_mfma_f32_32x32x16_bf16 v[80:95], v[148:151], v[144:147], v[80:95]
  ds_read_b128 v[176:179], v7 offset:32768
  ds_read_b64_tr_b16 v[180:181], v10 offset:38912
  ds_read_b64_tr_b16 v[182:183], v10 offset:39424
  v_mfma_f32_32x32x16_bf16 v[192:207], v[152:155], v[144:147], v[192:207]
  ds_read_b64_tr_b16 v[184:185], v10 offset:47104
  ds_read_b64_tr_b16 v[186:187], v10 offset:47616
  v_mfma_f32_32x32x16_bf16 v[208:223], v[144:147], v[156:159], v[208:223]
  ds_read_b64_tr_b16 v[188:189], v10 offset:55296
  ds_read_b64_tr_b16 v[190:191], v10 offset:55808
  s_waitcnt lgkmcnt(0)
  s_cmp_lg_u32 s57, 0
  s_cbranch_scc1 P1_AB_O
  s_barrier
P1_AB_O:
  v_xor_b32 v4, 0x10000, v4
  v_xor_b32 v5, 0x10000, v5
  v_xor_b32 v6, 0x10000, v6
  v_xor_b32 v7, 0x10000, v7
  v_xor_b32 v10, 0x10000, v10
  v_mfma_f32_32x32x16_bf16 v[80:95], v[164:167], v[160:163], v[80:95]
  ds_read_b128 v[128:131], v4 offset:0
  ds_read_b64_tr_b16 v[132:133], v10 offset:0
  ds_read_b64_tr_b16 v[134:135], v10 offset:512
  v_mfma_f32_32x32x16_bf16 v[192:207], v[168:171], v[160:163], v[192:207]
  ds_read_b64_tr_b16 v[136:137], v10 offset:8192
  ds_read_b64_tr_b16 v[138:139], v10 offset:8704
  v_mfma_f32_32x32x16_bf16 v[208:223], v[160:163], v[172:175], v[208:223]
  ds_read_b64_tr_b16 v[140:141], v10 offset:16384
  ds_read_b64_tr_b16 v[142:143], v10 offset:16896
  s_waitcnt lgkmcnt(7)
  v_mfma_f32_32x32x16_bf16 v[80:95], v[180:183], v[176:179], v[80:95]
  ds_read_b128 v[144:147], v5 offset:0
  ds_read_b64_tr_b16 v[148:149], v10 offset:2048
  ds_read_b64_tr_b16 v[150:151], v10 offset:2560
  v_mfma_f32_32x32x16_bf16 v[192:207], v[184:187], v[176:179], v[192:207]
  ds_read_b64_tr_b16 v[152:153], v10 offset:10240
  ds_read_b64_tr_b16 v[154:155], v10 offset:10752
  v_mfma_f32_32x32x16_bf16 v[208:223], v[176:179], v[188:191], v[208:223]
  ds_read_b64_tr_b16 v[156:157], v10 offset:18432
  ds_read_b64_tr_b16 v[158:159], v10 offset:18944
  s_add_u32 s57, s57, 1
  s_cmp_lt_u32 s57, 3
  s_cbranch_scc1 P1B_LOOP
  s_waitcnt lgkmcnt(0)
  s_branch P1_DONE
P1_ABAR:
  s_waitcnt vmcnt(0)
  s_barrier
  s_cmp_lg_u32 s3, 0
  s_cbranch_scc1 P1_AB_E
  s_mul_i32 s58, s7, 4096
  s_lshl_b32 s59, s6, 3
  s_add_u32 s58, s58, s59
  s_add_u32 s58, s58, 0x1800000
  v_mov_b32 v22, s58
  v_mov_b32 v20, s62
  v_mov_b32 v21, s63
  s_mov_b64 exec, 1
  global_store_dwordx2 v22, v[20:21], s[48:49] sc1
  s_mov_b64 exec, -1
  s_branch P1_AB_E
P1_LOADER:
  s_sub_u32 s50, s3, 4
  v_lshrrev_b32 v2, 3, v1
  v_lshrrev_b32 v3, 1, v2
  v_and_b32 v4, 7, v1
  v_xor_b32 v4, v4, v3
  v_lshlrev_b32 v4, 4, v4
  v_lshlrev_b32 v5, 10, v2
  v_add_u32 v5, v5, v4
  v_xor_b32 v6, 64, v5
  v_bfe_u32 v3, v1, 4, 1
  v_lshlrev_b32 v3, 2, v3
  v_and_b32 v4, 7, v1
  v_xor_b32 v4, v4, v3
  v_lshlrev_b32 v4, 4, v4
  v_mul_u32_u24 v7, 3072, v2
  v_add_u32 v7, v7, v4
  s_lshl_b32 s51, s6, 6
  s_lshl_b32 s52, s50, 4
  s_add_u32 s51, s51, s52
  s_lshl_b32 s51, s51, 10
  s_mul_i32 s52, s50, 49152
  s_lshl_b32 s53, s7, 7
  s_add_u32 s52, s52, s53
  s_lshl_b32 s53, s50, 11
  s_add_u32 s54, s53, 0x2000
  s_mov_b32 s57, 0
LD_LOOP:
  s_cmp_lg_u32 s57, 8
  s_cbranch_scc1 LD_NOSW
  v_mov_b32 v22, 0
  global_load_dwordx2 v[20:21], v22, s[46:47] sc1
  s_mov_b64 s[12:13], s[24:25]
  s_mov_b64 s[16:17], s[28:29]
LD_NOSW:
  s_add_u32 s55, s8, s57
  s_and_b32 s55, s55, 7
  s_lshl_b32 s56, s55, 7
  s_add_u32 s56, s56, s51
  s_mul_i32 s55, s55, 196608
  s_add_u32 s55, s55, s52
  s_and_b32 s59, s57, 3
  s_lshl_b32 s59, s59, 15
  s_add_u32 s60, s59, s53
  s_add_u32 s61, s59, s54
  s_add_u32 m0, s60, 0
  s_add_u32 s58, s56, 0
  buffer_load_dwordx4 v5, s[12:15], s58 offen lds
  s_add_u32 m0, s60, 1024
  s_add_u32 s58, s56, 8192
  buffer_load_dwordx4 v6, s[12:15], s58 offen lds
  s_add_u32 m0, s61, 0
  s_add_u32 s58, s55, 0
  buffer_load_dwordx4 v7, s[16:19], s58 offen lds
  s_add_u32 m0, s61, 1024
  s_add_u32 s58, s55, 24576
  buffer_load_dwordx4 v7, s[16:19], s58 offen lds
  s_add_u32 m0, s61, 8192
  s_add_u32 s58, s55, 1024
  buffer_load_dwordx4 v7, s[16:19], s58 offen lds
  s_add_u32 m0, s61, 9216
  s_add_u32 s58, s55, 25600
  buffer_load_dwordx4 v7, s[16:19], s58 offen lds
  s_add_u32 m0, s61, 16384
  s_add_u32 s58, s55, 2048
  buffer_load_dwordx4 v7, s[16:19], s58 offen lds
  s_add_u32 m0, s61, 17408
  s_add_u32 s58, s55, 26624
  buffer_load_dwordx4 v7, s[16:19], s58 offen lds
  s_add_u32 s57, s57, 1
  s_cmp_eq_u32 s57, 1
  s_cbranch_scc1 LD_LOOP
  s_cmp_eq_u32 s57, 3
  s_cbranch_scc1 LD_LOOP
  s_cmp_eq_u32 s57, 2
  s_cbranch_scc1 LD_W8
  s_cmp_eq_u32 s57, 16
  s_cbranch_scc1 LD_W0
  s_waitcnt vmcnt(16)
  s_barrier
  s_branch LD_LOOP
LD_W8:
  s_waitcnt vmcnt(8)
  s_barrier
  s_branch LD_LOOP
LD_W0:
  s_waitcnt vmcnt(0)
  s_barrier
  v_readfirstlane_b32 s62, v20
  v_readfirstlane_b32 s63, v21
  s_nop 3
  s_cmp_lg_u32 s62, 0
  s_cbranch_scc1 TOK7_HAVE
  v_mov_b32 v22, 0
  s_mov_b64 exec, 1
  s_mov_b32 s57, 0x40000
TOK7_POLL:
  global_load_dwordx2 v[20:21], v22, s[46:47] sc1
  s_waitcnt vmcnt(0)
  v_readfirstlane_b32 s62, v20
  v_readfirstlane_b32 s63, v21
  s_nop 3
  s_cmp_lg_u32 s62, 0
  s_cbranch_scc1 TOK7_FIN
  s_sleep 8
  s_sub_u32 s57, s57, 1
  s_cmp_lg_u32 s57, 0
  s_cbranch_scc1 TOK7_POLL
TOK7_FIN:
  s_mov_b64 exec, -1
TOK7_HAVE:
  s_and_b32 s50, s5, 3
  s_lshl_b32 s51, s4, 2
  s_add_u32 s50, s50, s51
  s_lshr_b32 s51, s50, 2
  s_mul_i32 s51, s51, 4096
  s_add_u32 s51, s51, 0x1800000
  v_lshlrev_b32 v2, 3, v1
  v_add_u32 v2, s51, v2
  s_mov_b64 exec, 0xffffffff
  s_mov_b32 s57, 0x40000
S1A_POLL:
  global_load_dwordx2 v[4:5], v2, s[48:49] sc1
  s_waitcnt vmcnt(0)
  v_cmp_ne_u32 vcc, s62, v4
  v_cmp_ne_u32 s[60:61], s63, v5
  s_nop 4
  s_or_b64 vcc, vcc, s[60:61]
  s_cbranch_vccz S1A_POLLED
  s_sleep 8
  s_sub_u32 s57, s57, 1
  s_cmp_lg_u32 s57, 0
  s_cbranch_scc1 S1A_POLL
S1A_POLLED:
  s_mov_b64 exec, -1
  s_lshl_b32 s51, s50, 17
  s_add_u32 s51, s51, 0x400000
  s_sub_u32 s52, s3, 4
  s_lshl_b32 s53, s52, 13
  s_add_u32 s54, s53, 0x20000
  s_add_u32 s53, s53, s51
  s_add_u32 m0, s54, 0
  s_add_u32 s55, s53, 0
  buffer_load_dwordx4 v17, s[20:23], s55 offen sc1 lds
  s_add_u32 m0, s54, 1024
  s_add_u32 s55, s53, 1024
  buffer_load_dwordx4 v17, s[20:23], s55 offen sc1 lds
  s_add_u32 m0, s54, 2048
  s_add_u32 s55, s53, 2048
  buffer_load_dwordx4 v17, s[20:23], s55 offen sc1 lds
  s_add_u32 m0, s54, 3072
  s_add_u32 s55, s53, 3072
  buffer_load_dwordx4 v17, s[20:23], s55 offen sc1 lds
  s_add_u32 m0, s54, 4096
  s_add_u32 s55, s53, 4096
  buffer_load_dwordx4 v17, s[20:23], s55 offen sc1 lds
  s_add_u32 m0, s54, 5120
  s_add_u32 s55, s53, 5120
  buffer_load_dwordx4 v17, s[20:23], s55 offen sc1 lds
  s_add_u32 m0, s54, 6144
  s_add_u32 s55, s53, 6144
  buffer_load_dwordx4 v17, s[20:23], s55 offen sc1 lds
  s_add_u32 m0, s54, 7168
  s_add_u32 s55, s53, 7168
  buffer_load_dwordx4 v17, s[20:23], s55 offen sc1 lds
  s_lshr_b32 s53, s5, 2
  s_lshl_b32 s53, s53, 3
  s_lshl_b32 s52, s52, 1
  s_add_u32 s52, s52, s53
  s_lshl_b32 s53, s50, 6
  s_add_u32 s54, s53, s52
  s_lshl_b32 s54, s54, 10
  buffer_load_dwordx4 v[8:11], v17, s[20:23], s54 offen sc1
  buffer_load_dwordx4 v[12:15], v17, s[20:23], s54 offen offset:1024 sc1
  v_and_b32 v28, 27, v1
  v_cmp_eq_u32 vcc, 16, v28
  v_mov_b32 v29, 0x3f803f80
  s_nop 1
  v_cndmask_b32 v176, 0, v29, vcc
  v_mov_b32 v177, v176
  v_mov_b32 v178, v176
  v_mov_b32 v179, v176
  v_mov_b32 v180, v176
  v_mov_b32 v181, v176
  v_mov_b32 v182, v176
  v_mov_b32 v183, v176
  v_mov_b32 v184, v176
  v_mov_b32 v185, v176
  v_mov_b32 v186, v176
  v_mov_b32 v187, v176
  v_mov_b32 v188, v176
  v_mov_b32 v189, v176
  v_mov_b32 v190, v176
  v_mov_b32 v191, v176
  v_mov_b32 v192, 0
  v_mov_b32 v193, 0
  v_mov_b32 v194, 0
  v_mov_b32 v195, 0
  v_mov_b32 v196, 0
  v_mov_b32 v197, 0
  v_mov_b32 v198, 0
  v_mov_b32 v199, 0
  v_mov_b32 v200, 0
  v_mov_b32 v201, 0
  v_mov_b32 v202, 0
  v_mov_b32 v203, 0
  v_mov_b32 v204, 0
  v_mov_b32 v205, 0
  v_mov_b32 v206, 0
  v_mov_b32 v207, 0
  v_mov_b32 v208, 0
  v_mov_b32 v209, 0
  v_mov_b32 v210, 0
  v_mov_b32 v211, 0
  v_mov_b32 v212, 0
  v_mov_b32 v213, 0
  v_mov_b32 v214, 0
  v_mov_b32 v215, 0
  v_mov_b32 v216, 0
  v_mov_b32 v217, 0
  v_mov_b32 v218, 0
  v_mov_b32 v219, 0
  v_mov_b32 v220, 0
  v_mov_b32 v221, 0
  v_mov_b32 v222, 0
  v_mov_b32 v223, 0
  v_mov_b32 v236, 0
  v_mov_b32 v237, 0
  v_mov_b32 v238, 0
  v_mov_b32 v239, 0
  s_waitcnt vmcnt(0)
P1_LDONE:
P1_DONE:
  s_barrier
  s_and_b32 s6, s5, 3
  s_lshl_b32 s7, s4, 2
  s_add_u32 s6, s6, s7
  s_lshr_b32 s7, s5, 2
  v_mov_b32 v2, v17
  s_and_b32 s11, s3, 3
  s_lshl_b32 s27, s7, 3
  s_lshl_b32 s50, s11, 1
  s_add_u32 s27, s27, s50
  s_add_u32 s28, s27, 1
  s_lshl_b32 s14, s6, 6
  s_lshl_b32 s9, s6, 17
  s_add_u32 s9, s9, 0x400000
  v_lshrrev_b32 v3, 5, v1
  v_lshlrev_b32 v3, 8, v3
  v_and_b32 v4, 15, v1
  v_lshlrev_b32 v4, 4, v4
  v_add_u32 v3, v3, v4
  v_add_u32 v3, 0x400, v3
  s_mov_b32 s16, 0x0000ffff
  s_mov_b32 s17, 0x0000ffff
  s_lshl_b32 s64, s4, 2
  s_and_b32 s66, s5, 3
  s_add_u32 s64, s64, s66
  s_lshr_b32 s65, s5, 2
  s_lshr_b32 s72, s64, 2
  s_mul_i32 s72, s72, 4096
  s_add_u32 s72, s72, 0x1830000
  v_lshlrev_b32 v168, 3, v1
  v_add_u32 v168, s72, v168
  s_cmp_lt_u32 s3, 4
  s_cbranch_scc1 LAG
  s_setprio 1
  v_mov_b32 v28, v176
  v_mov_b32 v29, v176
  v_mov_b32 v30, v176
  v_mov_b32 v31, v176
  v_mov_b32 v32, v176
  v_mov_b32 v33, v176
  v_mov_b32 v34, v176
  v_mov_b32 v35, v176
  v_mov_b32 v36, v176
  v_mov_b32 v37, v176
  v_mov_b32 v38, v176
  v_mov_b32 v39, v176
  v_mov_b32 v40, v176
  v_mov_b32 v41, v176
  v_mov_b32 v42, v176
  v_mov_b32 v43, v176
  v_add_u32 v6, 0x20000, v2
  v_add_u32 v7, 0x20000, v3
  ds_read_b128 v[20:23], v6
  ds_read_b128 v[24:27], v6 offset:2048
  s_mov_b64 exec, s[16:17]
  ds_read_b128 v[176:179], v7
  ds_read_b128 v[180:183], v7 offset:512
  ds_read_b128 v[184:187], v7 offset:2048
  ds_read_b128 v[188:191], v7 offset:2560
  s_mov_b64 exec, -1
  v_mov_b32 v240, -1
  v_mov_b32 v241, -1
  v_mov_b32 v242, -1
  v_mov_b32 v243, -1
  s_lshl_b32 s13, s27, 5
  s_add_u32 s13, s13, s6
  s_lshl_b32 s13, s13, 10
  s_add_u32 s13, s13, 0xc00000
  buffer_store_dwordx4 v[240:243], v2, s[20:23], s13 offen sc1
  s_add_u32 s13, s13, 0x8000
  buffer_store_dwordx4 v[240:243], v2, s[20:23], s13 offen sc1
  s_waitcnt lgkmcnt(5)
  v_mfma_f32_32x32x16_bf16 v[64:79], v[20:23], v[8:11], 0
  v_mfma_f32_32x32x16_bf16 v[80:95], v[20:23], v[12:15], 0
  s_mov_b32 s10, 0x68
  s_mov_b32 s24, 0
  s_mov_b32 s25, 0x20000
  s_nop 9
  v_max3_f32 v4, v64, v65, v66
  v_max3_f32 v4, v4, v67, v68
  v_max3_f32 v4, v4, v69, v70
  v_max3_f32 v4, v4, v71, v72
  v_max3_f32 v4, v4, v73, v74
  v_max3_f32 v4, v4, v75, v76
  v_max3_f32 v4, v4, v77, v78
  v_max_f32 v4, v4, v79
  v_max3_f32 v160, v80, v81, v82
  v_max3_f32 v160, v160, v83, v84
  v_max3_f32 v160, v160, v85, v86
  v_max3_f32 v160, v160, v87, v88
  v_max3_f32 v160, v160, v89, v90
  v_max3_f32 v160, v160, v91, v92
  v_max3_f32 v160, v160, v93, v94
  v_max_f32 v160, v160, v95
  v_mov_b32 v5, v4
  s_nop 1
  v_permlane32_swap_b32 v4, v5
  s_nop 1
  v_max_f32 v4, v4, v5
  v_mov_b32 v161, v160
  s_nop 1
  v_permlane32_swap_b32 v160, v161
  s_nop 1
  v_max_f32 v160, v160, v161
  v_sub_f32 v128, 0, v4
  v_sub_f32 v129, 0, v4
  v_sub_f32 v130, 0, v4
  v_sub_f32 v131, 0, v4
  v_sub_f32 v132, 0, v4
  v_sub_f32 v133, 0, v4
  v_sub_f32 v134, 0, v4
  v_sub_f32 v135, 0, v4
  v_sub_f32 v136, 0, v4
  v_sub_f32 v137, 0, v4
  v_sub_f32 v138, 0, v4
  v_sub_f32 v139, 0, v4
  v_sub_f32 v140, 0, v4
  v_sub_f32 v141, 0, v4
  v_sub_f32 v142, 0, v4
  v_sub_f32 v143, 0, v4
  s_nop 1
  v_mfma_f32_32x32x16_bf16 v[64:79], v[20:23], v[8:11], v[128:143]
  v_sub_f32 v144, 0, v160
  v_sub_f32 v145, 0, v160
  v_sub_f32 v146, 0, v160
  v_sub_f32 v147, 0, v160
  v_sub_f32 v148, 0, v160
  v_sub_f32 v149, 0, v160
  v_sub_f32 v150, 0, v160
  v_sub_f32 v151, 0, v160
  v_sub_f32 v152, 0, v160
  v_sub_f32 v153, 0, v160
  v_sub_f32 v154, 0, v160
  v_sub_f32 v155, 0, v160
  v_sub_f32 v156, 0, v160
  v_sub_f32 v157, 0, v160
  v_sub_f32 v158, 0, v160
  v_sub_f32 v159, 0, v160
.p2align 6
A_LOOP:
  s_add_u32 s26, s25, 0x4000
  s_cmp_eq_u32 s24, 1
  s_cselect_b32 s25, 0, s26
  v_add_u32 v166, s25, v2
  v_add_u32 v167, s25, v3
  s_waitcnt lgkmcnt(0)
  v_mfma_f32_32x32x16_bf16 v[80:95], v[20:23], v[12:15], v[144:159]
  ds_read_b128 v[20:23], v6 offset:4096
  v_exp_f32 v64, v64
  v_exp_f32 v65, v65
  v_exp_f32 v66, v66
  v_exp_f32 v67, v67
  v_cvt_pk_bf16_f32 v224, v64, v65
  v_mfma_f32_32x32x16_bf16 v[208:223], v[40:43], v[236:239], v[208:223]
  s_mov_b64 exec, s[16:17]
  ds_read_b128 v[28:31], v7 offset:4096
  ds_read_b128 v[32:35], v7 offset:4608
  ds_read_b128 v[36:39], v7 offset:6144
  ds_read_b128 v[40:43], v7 offset:6656
  s_mov_b64 exec, -1
  v_exp_f32 v68, v68
  v_exp_f32 v69, v69
  v_cvt_pk_bf16_f32 v225, v66, v67
  v_exp_f32 v70, v70
  v_exp_f32 v71, v71
  v_cvt_pk_bf16_f32 v226, v68, v69
  v_exp_f32 v72, v72
  v_exp_f32 v73, v73
  v_cvt_pk_bf16_f32 v227, v70, v71
  v_exp_f32 v74, v74
  v_exp_f32 v75, v75
  v_cvt_pk_bf16_f32 v228, v72, v73
  v_mfma_f32_32x32x16_bf16 v[192:207], v[176:179], v[224:227], v[192:207]
  v_exp_f32 v76, v76
  v_exp_f32 v77, v77
  v_cvt_pk_bf16_f32 v229, v74, v75
  v_exp_f32 v78, v78
  v_exp_f32 v79, v79
  v_cvt_pk_bf16_f32 v230, v76, v77
  v_cvt_pk_bf16_f32 v231, v78, v79
  v_mfma_f32_32x32x16_bf16 v[64:79], v[24:27], v[8:11], v[128:143]
  v_exp_f32 v80, v80
  v_exp_f32 v81, v81
  v_exp_f32 v82, v82
  v_exp_f32 v83, v83
  v_cvt_pk_bf16_f32 v232, v80, v81
  v_mfma_f32_32x32x16_bf16 v[192:207], v[180:183], v[228:231], v[192:207]
  v_exp_f32 v84, v84
  v_exp_f32 v85, v85
  v_cvt_pk_bf16_f32 v233, v82, v83
  v_exp_f32 v86, v86
  v_exp_f32 v87, v87
  v_cvt_pk_bf16_f32 v234, v84, v85
  v_exp_f32 v88, v88
  v_exp_f32 v89, v89
  v_cvt_pk_bf16_f32 v235, v86, v87
  v_exp_f32 v90, v90
  v_exp_f32 v91, v91
  v_cvt_pk_bf16_f32 v236, v88, v89
  v_mfma_f32_32x32x16_bf16 v[208:223], v[176:179], v[232:235], v[208:223]
  v_exp_f32 v92, v92
  v_exp_f32 v93, v93
  v_cvt_pk_bf16_f32 v237, v90, v91
  v_exp_f32 v94, v94
  v_exp_f32 v95, v95
  v_cvt_pk_bf16_f32 v238, v92, v93
  v_cvt_pk_bf16_f32 v239, v94, v95
  s_waitcnt lgkmcnt(0)
  v_mfma_f32_32x32x16_bf16 v[80:95], v[24:27], v[12:15], v[144:159]
  ds_read_b128 v[24:27], v6 offset:6144
  v_exp_f32 v64, v64
  v_exp_f32 v65, v65
  v_exp_f32 v66, v66
  v_exp_f32 v67, v67
  v_cvt_pk_bf16_f32 v224, v64, v65
  v_mfma_f32_32x32x16_bf16 v[208:223], v[180:183], v[236:239], v[208:223]
  v_exp_f32 v68, v68
  v_exp_f32 v69, v69
  v_cvt_pk_bf16_f32 v225, v66, v67
  v_exp_f32 v70, v70
  v_exp_f32 v71, v71
  v_cvt_pk_bf16_f32 v226, v68, v69
  v_exp_f32 v72, v72
  v_exp_f32 v73, v73
  v_cvt_pk_bf16_f32 v227, v70, v71
  v_exp_f32 v74, v74
  v_exp_f32 v75, v75
  v_cvt_pk_bf16_f32 v228, v72, v73
  v_mfma_f32_32x32x16_bf16 v[192:207], v[184:187], v[224:227], v[192:207]
  v_exp_f32 v76, v76
  v_exp_f32 v77, v77
  v_cvt_pk_bf16_f32 v229, v74, v75
  v_exp_f32 v78, v78
  v_exp_f32 v79, v79
  v_cvt_pk_bf16_f32 v230, v76, v77
  v_cvt_pk_bf16_f32 v231, v78, v79
  v_mfma_f32_32x32x16_bf16 v[64:79], v[20:23], v[8:11], v[128:143]
  v_exp_f32 v80, v80
  v_exp_f32 v81, v81
  v_exp_f32 v82, v82
  v_exp_f32 v83, v83
  v_cvt_pk_bf16_f32 v232, v80, v81
  v_mfma_f32_32x32x16_bf16 v[192:207], v[188:191], v[228:231], v[192:207]
  v_exp_f32 v84, v84
  v_exp_f32 v85, v85
  v_cvt_pk_bf16_f32 v233, v82, v83
  v_exp_f32 v86, v86
  v_exp_f32 v87, v87
  v_cvt_pk_bf16_f32 v234, v84, v85
  v_exp_f32 v88, v88
  v_exp_f32 v89, v89
  v_cvt_pk_bf16_f32 v235, v86, v87
  v_exp_f32 v90, v90
  v_exp_f32 v91, v91
  v_cvt_pk_bf16_f32 v236, v88, v89
  v_mfma_f32_32x32x16_bf16 v[208:223], v[184:187], v[232:235], v[208:223]
  v_exp_f32 v92, v92
  v_exp_f32 v93, v93
  v_cvt_pk_bf16_f32 v237, v90, v91
  v_exp_f32 v94, v94
  v_exp_f32 v95, v95
  v_cvt_pk_bf16_f32 v238, v92, v93
  v_cvt_pk_bf16_f32 v239, v94, v95
  s_waitcnt lgkmcnt(0)
  v_mfma_f32_32x32x16_bf16 v[80:95], v[20:23], v[12:15], v[144:159]
  ds_read_b128 v[20:23], v6 offset:8192
  v_exp_f32 v64, v64
  v_exp_f32 v65, v65
  v_exp_f32 v66, v66
  v_exp_f32 v67, v67
  v_cvt_pk_bf16_f32 v224, v64, v65
  v_mfma_f32_32x32x16_bf16 v[208:223], v[188:191], v[236:239], v[208:223]
  s_mov_b64 exec, s[16:17]
  ds_read_b128 v[176:179], v7 offset:8192
  ds_read_b128 v[180:183], v7 offset:8704
  ds_read_b128 v[184:187], v7 offset:10240
  ds_read_b128 v[188:191], v7 offset:10752
  s_mov_b64 exec, -1
  v_exp_f32 v68, v68
  v_exp_f32 v69, v69
  v_cvt_pk_bf16_f32 v225, v66, v67
  v_exp_f32 v70, v70
  v_exp_f32 v71, v71
  v_cvt_pk_bf16_f32 v226, v68, v69
  v_exp_f32 v72, v72
  v_exp_f32 v73, v73
  v_cvt_pk_bf16_f32 v227, v70, v71
  v_exp_f32 v74, v74
  v_exp_f32 v75, v75
  v_cvt_pk_bf16_f32 v228, v72, v73
  v_mfma_f32_32x32x16_bf16 v[192:207], v[28:31], v[224:227], v[192:207]
  v_exp_f32 v76, v76
  v_exp_f32 v77, v77
  v_cvt_pk_bf16_f32 v229, v74, v75
  v_exp_f32 v78, v78
  v_exp_f32 v79, v79
  v_cvt_pk_bf16_f32 v230, v76, v77
  v_cvt_pk_bf16_f32 v231, v78, v79
  v_mfma_f32_32x32x16_bf16 v[64:79], v[24:27], v[8:11], v[128:143]
  v_exp_f32 v80, v80
  v_exp_f32 v81, v81
  v_exp_f32 v82, v82
  v_exp_f32 v83, v83
  v_cvt_pk_bf16_f32 v232, v80, v81
  v_mfma_f32_32x32x16_bf16 v[192:207], v[32:35], v[228:231], v[192:207]
  v_exp_f32 v84, v84
  v_exp_f32 v85, v85
  v_cvt_pk_bf16_f32 v233, v82, v83
  v_exp_f32 v86, v86
  v_exp_f32 v87, v87
  v_cvt_pk_bf16_f32 v234, v84, v85
  v_exp_f32 v88, v88
  v_exp_f32 v89, v89
  v_cvt_pk_bf16_f32 v235, v86, v87
  v_exp_f32 v90, v90
  v_exp_f32 v91, v91
  v_cvt_pk_bf16_f32 v236, v88, v89
  v_mfma_f32_32x32x16_bf16 v[208:223], v[28:31], v[232:235], v[208:223]
  v_exp_f32 v92, v92
  v_exp_f32 v93, v93
  v_cvt_pk_bf16_f32 v237, v90, v91
  v_exp_f32 v94, v94
  v_exp_f32 v95, v95
  v_cvt_pk_bf16_f32 v238, v92, v93
  v_cvt_pk_bf16_f32 v239, v94, v95
  s_waitcnt lgkmcnt(0)
  v_mfma_f32_32x32x16_bf16 v[80:95], v[24:27], v[12:15], v[144:159]
  ds_read_b128 v[24:27], v6 offset:10240
  v_exp_f32 v64, v64
  v_exp_f32 v65, v65
  v_exp_f32 v66, v66
  v_exp_f32 v67, v67
  v_cvt_pk_bf16_f32 v224, v64, v65
  v_mfma_f32_32x32x16_bf16 v[208:223], v[32:35], v[236:239], v[208:223]
  v_exp_f32 v68, v68
  v_exp_f32 v69, v69
  v_cvt_pk_bf16_f32 v225, v66, v67
  v_exp_f32 v70, v70
  v_exp_f32 v71, v71
  v_cvt_pk_bf16_f32 v226, v68, v69
  v_exp_f32 v72, v72
  v_exp_f32 v73, v73
  v_cvt_pk_bf16_f32 v227, v70, v71
  v_exp_f32 v74, v74
  v_exp_f32 v75, v75
  v_cvt_pk_bf16_f32 v228, v72, v73
  v_mfma_f32_32x32x16_bf16 v[192:207], v[36:39], v[224:227], v[192:207]
  v_exp_f32 v76, v76
  v_exp_f32 v77, v77
  v_cvt_pk_bf16_f32 v229, v74, v75
  v_exp_f32 v78, v78
  v_exp_f32 v79, v79
  v_cvt_pk_bf16_f32 v230, v76, v77
  v_cvt_pk_bf16_f32 v231, v78, v79
  v_mfma_f32_32x32x16_bf16 v[64:79], v[20:23], v[8:11], v[128:143]
  v_exp_f32 v80, v80
  v_exp_f32 v81, v81
  v_exp_f32 v82, v82
  v_exp_f32 v83, v83
  v_cvt_pk_bf16_f32 v232, v80, v81
  v_mfma_f32_32x32x16_bf16 v[192:207], v[40:43], v[228:231], v[192:207]
  v_exp_f32 v84, v84
  v_exp_f32 v85, v85
  v_cvt_pk_bf16_f32 v233, v82, v83
  v_exp_f32 v86, v86
  v_exp_f32 v87, v87
  v_cvt_pk_bf16_f32 v234, v84, v85
  v_exp_f32 v88, v88
  v_exp_f32 v89, v89
  v_cvt_pk_bf16_f32 v235, v86, v87
  v_exp_f32 v90, v90
  v_exp_f32 v91, v91
  v_cvt_pk_bf16_f32 v236, v88, v89
  v_mfma_f32_32x32x16_bf16 v[208:223], v[36:39], v[232:235], v[208:223]
  v_exp_f32 v92, v92
  v_exp_f32 v93, v93
  v_cvt_pk_bf16_f32 v237, v90, v91
  v_exp_f32 v94, v94
  v_exp_f32 v95, v95
  v_cvt_pk_bf16_f32 v238, v92, v93
  v_cvt_pk_bf16_f32 v239, v94, v95
  s_cmp_eq_u32 s24, 1
  s_cbranch_scc1 A_HOOKM
A_MID:
  s_waitcnt lgkmcnt(0)
  v_mfma_f32_32x32x16_bf16 v[80:95], v[20:23], v[12:15], v[144:159]
  ds_read_b128 v[20:23], v6 offset:12288
  v_exp_f32 v64, v64
  v_exp_f32 v65, v65
  v_exp_f32 v66, v66
  v_exp_f32 v67, v67
  v_cvt_pk_bf16_f32 v224, v64, v65
  v_mfma_f32_32x32x16_bf16 v[208:223], v[40:43], v[236:239], v[208:223]
  s_mov_b64 exec, s[16:17]
  ds_read_b128 v[28:31], v7 offset:12288
  ds_read_b128 v[32:35], v7 offset:12800
  ds_read_b128 v[36:39], v7 offset:14336
  ds_read_b128 v[40:43], v7 offset:14848
  s_mov_b64 exec, -1
  v_exp_f32 v68, v68
  v_exp_f32 v69, v69
  v_cvt_pk_bf16_f32 v225, v66, v67
  v_exp_f32 v70, v70
  v_exp_f32 v71, v71
  v_cvt_pk_bf16_f32 v226, v68, v69
  v_exp_f32 v72, v72
  v_exp_f32 v73, v73
  v_cvt_pk_bf16_f32 v227, v70, v71
  v_exp_f32 v74, v74
  v_exp_f32 v75, v75
  v_cvt_pk_bf16_f32 v228, v72, v73
  v_mfma_f32_32x32x16_bf16 v[192:207], v[176:179], v[224:227], v[192:207]
  v_exp_f32 v76, v76
  v_exp_f32 v77, v77
  v_cvt_pk_bf16_f32 v229, v74, v75
  v_exp_f32 v78, v78
  v_exp_f32 v79, v79
  v_cvt_pk_bf16_f32 v230, v76, v77
  v_cvt_pk_bf16_f32 v231, v78, v79
  v_mfma_f32_32x32x16_bf16 v[64:79], v[24:27], v[8:11], v[128:143]
  v_exp_f32 v80, v80
  v_exp_f32 v81, v81
  v_exp_f32 v82, v82
  v_exp_f32 v83, v83
  v_cvt_pk_bf16_f32 v232, v80, v81
  v_mfma_f32_32x32x16_bf16 v[192:207], v[180:183], v[228:231], v[192:207]
  v_exp_f32 v84, v84
  v_exp_f32 v85, v85
  v_cvt_pk_bf16_f32 v233, v82, v83
  v_exp_f32 v86, v86
  v_exp_f32 v87, v87
  v_cvt_pk_bf16_f32 v234, v84, v85
  v_exp_f32 v88, v88
  v_exp_f32 v89, v89
  v_cvt_pk_bf16_f32 v235, v86, v87
  v_exp_f32 v90, v90
  v_exp_f32 v91, v91
  v_cvt_pk_bf16_f32 v236, v88, v89
  v_mfma_f32_32x32x16_bf16 v[208:223], v[176:179], v[232:235], v[208:223]
  v_exp_f32 v92, v92
  v_exp_f32 v93, v93
  v_cvt_pk_bf16_f32 v237, v90, v91
  v_exp_f32 v94, v94
  v_exp_f32 v95, v95
  v_cvt_pk_bf16_f32 v238, v92, v93
  v_cvt_pk_bf16_f32 v239, v94, v95
  s_waitcnt lgkmcnt(0)
  v_mfma_f32_32x32x16_bf16 v[80:95], v[24:27], v[12:15], v[144:159]
  ds_read_b128 v[24:27], v6 offset:14336
  v_exp_f32 v64, v64
  v_exp_f32 v65, v65
  v_exp_f32 v66, v66
  v_exp_f32 v67, v67
  v_cvt_pk_bf16_f32 v224, v64, v65
  v_mfma_f32_32x32x16_bf16 v[208:223], v[180:183], v[236:239], v[208:223]
  v_exp_f32 v68, v68
  v_exp_f32 v69, v69
  v_cvt_pk_bf16_f32 v225, v66, v67
  v_exp_f32 v70, v70
  v_exp_f32 v71, v71
  v_cvt_pk_bf16_f32 v226, v68, v69
  v_exp_f32 v72, v72
  v_exp_f32 v73, v73
  v_cvt_pk_bf16_f32 v227, v70, v71
  v_exp_f32 v74, v74
  v_exp_f32 v75, v75
  v_cvt_pk_bf16_f32 v228, v72, v73
  v_mfma_f32_32x32x16_bf16 v[192:207], v[184:187], v[224:227], v[192:207]
  v_exp_f32 v76, v76
  v_exp_f32 v77, v77
  v_cvt_pk_bf16_f32 v229, v74, v75
  v_exp_f32 v78, v78
  v_exp_f32 v79, v79
  v_cvt_pk_bf16_f32 v230, v76, v77
  v_cvt_pk_bf16_f32 v231, v78, v79
  v_mfma_f32_32x32x16_bf16 v[64:79], v[20:23], v[8:11], v[128:143]
  v_exp_f32 v80, v80
  v_exp_f32 v81, v81
  v_exp_f32 v82, v82
  v_exp_f32 v83, v83
  v_cvt_pk_bf16_f32 v232, v80, v81
  v_mfma_f32_32x32x16_bf16 v[192:207], v[188:191], v[228:231], v[192:207]
  v_exp_f32 v84, v84
  v_exp_f32 v85, v85
  v_cvt_pk_bf16_f32 v233, v82, v83
  v_exp_f32 v86, v86
  v_exp_f32 v87, v87
  v_cvt_pk_bf16_f32 v234, v84, v85
  v_exp_f32 v88, v88
  v_exp_f32 v89, v89
  v_cvt_pk_bf16_f32 v235, v86, v87
  v_exp_f32 v90, v90
  v_exp_f32 v91, v91
  v_cvt_pk_bf16_f32 v236, v88, v89
  v_mfma_f32_32x32x16_bf16 v[208:223], v[184:187], v[232:235], v[208:223]
  v_exp_f32 v92, v92
  v_exp_f32 v93, v93
  v_cvt_pk_bf16_f32 v237, v90, v91
  v_exp_f32 v94, v94
  v_exp_f32 v95, v95
  v_cvt_pk_bf16_f32 v238, v92, v93
  v_cvt_pk_bf16_f32 v239, v94, v95
  s_waitcnt lgkmcnt(0)
  v_mfma_f32_32x32x16_bf16 v[80:95], v[20:23], v[12:15], v[144:159]
  ds_read_b128 v[20:23], v166 offset:0
  v_exp_f32 v64, v64
  v_exp_f32 v65, v65
  v_exp_f32 v66, v66
  v_exp_f32 v67, v67
  v_cvt_pk_bf16_f32 v224, v64, v65
  v_mfma_f32_32x32x16_bf16 v[208:223], v[188:191], v[236:239], v[208:223]
  s_mov_b64 exec, s[16:17]
  ds_read_b128 v[176:179], v167 offset:0
  ds_read_b128 v[180:183], v167 offset:512
  ds_read_b128 v[184:187], v167 offset:2048
  ds_read_b128 v[188:191], v167 offset:2560
  s_mov_b64 exec, -1
  v_exp_f32 v68, v68
  v_exp_f32 v69, v69
  v_cvt_pk_bf16_f32 v225, v66, v67
  v_exp_f32 v70, v70
  v_exp_f32 v71, v71
  v_cvt_pk_bf16_f32 v226, v68, v69
  v_exp_f32 v72, v72
  v_exp_f32 v73, v73
  v_cvt_pk_bf16_f32 v227, v70, v71
  v_exp_f32 v74, v74
  v_exp_f32 v75, v75
  v_cvt_pk_bf16_f32 v228, v72, v73
  v_mfma_f32_32x32x16_bf16 v[192:207], v[28:31], v[224:227], v[192:207]
  v_exp_f32 v76, v76
  v_exp_f32 v77, v77
  v_cvt_pk_bf16_f32 v229, v74, v75
  v_exp_f32 v78, v78
  v_exp_f32 v79, v79
  v_cvt_pk_bf16_f32 v230, v76, v77
  v_cvt_pk_bf16_f32 v231, v78, v79
  v_mfma_f32_32x32x16_bf16 v[64:79], v[24:27], v[8:11], v[128:143]
  v_exp_f32 v80, v80
  v_exp_f32 v81, v81
  v_exp_f32 v82, v82
  v_exp_f32 v83, v83
  v_cvt_pk_bf16_f32 v232, v80, v81
  v_mfma_f32_32x32x16_bf16 v[192:207], v[32:35], v[228:231], v[192:207]
  v_exp_f32 v84, v84
  v_exp_f32 v85, v85
  v_cvt_pk_bf16_f32 v233, v82, v83
  v_exp_f32 v86, v86
  v_exp_f32 v87, v87
  v_cvt_pk_bf16_f32 v234, v84, v85
  v_exp_f32 v88, v88
  v_exp_f32 v89, v89
  v_cvt_pk_bf16_f32 v235, v86, v87
  v_exp_f32 v90, v90
  v_exp_f32 v91, v91
  v_cvt_pk_bf16_f32 v236, v88, v89
  v_mfma_f32_32x32x16_bf16 v[208:223], v[28:31], v[232:235], v[208:223]
  v_exp_f32 v92, v92
  v_exp_f32 v93, v93
  v_cvt_pk_bf16_f32 v237, v90, v91
  v_exp_f32 v94, v94
  v_exp_f32 v95, v95
  v_cvt_pk_bf16_f32 v238, v92, v93
  v_cvt_pk_bf16_f32 v239, v94, v95
  s_waitcnt lgkmcnt(0)
  v_mfma_f32_32x32x16_bf16 v[80:95], v[24:27], v[12:15], v[144:159]
  ds_read_b128 v[24:27], v166 offset:2048
  v_exp_f32 v64, v64
  v_exp_f32 v65, v65
  v_exp_f32 v66, v66
  v_exp_f32 v67, v67
  v_cvt_pk_bf16_f32 v224, v64, v65
  v_mfma_f32_32x32x16_bf16 v[208:223], v[32:35], v[236:239], v[208:223]
  v_exp_f32 v68, v68
  v_exp_f32 v69, v69
  v_cvt_pk_bf16_f32 v225, v66, v67
  v_exp_f32 v70, v70
  v_exp_f32 v71, v71
  v_cvt_pk_bf16_f32 v226, v68, v69
  v_exp_f32 v72, v72
  v_exp_f32 v73, v73
  v_cvt_pk_bf16_f32 v227, v70, v71
  v_exp_f32 v74, v74
  v_exp_f32 v75, v75
  v_cvt_pk_bf16_f32 v228, v72, v73
  v_mfma_f32_32x32x16_bf16 v[192:207], v[36:39], v[224:227], v[192:207]
  v_exp_f32 v76, v76
  v_exp_f32 v77, v77
  v_cvt_pk_bf16_f32 v229, v74, v75
  v_exp_f32 v78, v78
  v_exp_f32 v79, v79
  v_cvt_pk_bf16_f32 v230, v76, v77
  v_cvt_pk_bf16_f32 v231, v78, v79
  v_mfma_f32_32x32x16_bf16 v[64:79], v[20:23], v[8:11], v[128:143]
  v_exp_f32 v80, v80
  v_exp_f32 v81, v81
  v_exp_f32 v82, v82
  v_exp_f32 v83, v83
  v_cvt_pk_bf16_f32 v232, v80, v81
  v_mfma_f32_32x32x16_bf16 v[192:207], v[40:43], v[228:231], v[192:207]
  v_exp_f32 v84, v84
  v_exp_f32 v85, v85
  v_cvt_pk_bf16_f32 v233, v82, v83
  v_exp_f32 v86, v86
  v_exp_f32 v87, v87
  v_cvt_pk_bf16_f32 v234, v84, v85
  v_exp_f32 v88, v88
  v_exp_f32 v89, v89
  v_cvt_pk_bf16_f32 v235, v86, v87
  v_exp_f32 v90, v90
  v_exp_f32 v91, v91
  v_cvt_pk_bf16_f32 v236, v88, v89
  v_mfma_f32_32x32x16_bf16 v[208:223], v[36:39], v[232:235], v[208:223]
  v_exp_f32 v92, v92
  v_exp_f32 v93, v93
  v_cvt_pk_bf16_f32 v237, v90, v91
  v_exp_f32 v94, v94
  v_exp_f32 v95, v95
  v_cvt_pk_bf16_f32 v238, v92, v93
  v_cvt_pk_bf16_f32 v239, v94, v95
  v_mov_b32 v6, v166
  v_mov_b32 v7, v167
  s_bitcmp1_b32 s10, s24
  s_cbranch_scc1 A_HOOK
A_NEXT:
  s_add_u32 s24, s24, 1
  s_cmp_lg_u32 s24, 8
  s_cbranch_scc1 A_LOOP
  v_mfma_f32_32x32x16_bf16 v[208:223], v[40:43], v[236:239], v[208:223]
  s_mov_b32 exec_hi, 0
  global_load_dwordx2 v[170:171], v168, s[48:49] sc1
  s_mov_b64 exec, -1
  s_waitcnt lgkmcnt(0)
  s_nop 13
  v_max3_f32 v4, |v192|, |v193|, |v194|
  v_max3_f32 v4, v4, |v195|, |v196|
  v_max3_f32 v4, v4, |v197|, |v198|
  v_max3_f32 v4, v4, |v199|, |v200|
  v_max3_f32 v4, v4, |v208|, |v209|
  v_max3_f32 v4, v4, |v210|, |v211|
  v_max3_f32 v4, v4, |v212|, |v213|
  v_max3_f32 v4, v4, |v214|, |v215|
  v_max_f32 v4, v4, |v216|
  v_add_f32 v5, v192, v193
  v_add_f32 v5, v5, v194
  v_add_f32 v5, v5, v195
  v_add_f32 v5, v5, v196
  v_add_f32 v5, v5, v197
  v_add_f32 v5, v5, v198
  v_add_f32 v5, v5, v199
  v_add_f32 v5, v5, v200
  v_add_f32 v5, v5, v208
  v_add_f32 v5, v5, v209
  v_add_f32 v5, v5, v210
  v_add_f32 v5, v5, v211
  v_add_f32 v5, v5, v212
  v_add_f32 v5, v5, v213
  v_add_f32 v5, v5, v214
  v_add_f32 v5, v5, v215
  v_add_f32 v5, v5, v216
  v_and_b32 v5, 0x7fffffff, v5
  v_max_i32 v4, v4, v5
  s_mov_b32 s25, 0x7b800000
  v_cmp_gt_i32 vcc, s25, v4
  s_nop 4
  s_cmp_eq_u64 vcc, -1
  s_cselect_b32 s25, 0, 1
  s_cmp_lg_u32 s25, 0
  s_cbranch_scc1 A_FALLBACK
A_FIN:
  v_rcp_f32 v5, v200
  s_lshl_b32 s13, s27, 5
  v_mul_f32 v192, v192, v5
  v_mul_f32 v193, v193, v5
  v_mul_f32 v194, v194, v5
  v_mul_f32 v195, v195, v5
  v_mul_f32 v196, v196, v5
  v_mul_f32 v197, v197, v5
  v_mul_f32 v198, v198, v5
  v_mul_f32 v199, v199, v5
  v_cvt_pk_bf16_f32 v64, v192, v193
  v_cvt_pk_bf16_f32 v65, v194, v195
  v_cvt_pk_bf16_f32 v66, v196, v197
  v_cvt_pk_bf16_f32 v67, v198, v199
  s_add_u32 s13, s13, s6
  s_lshl_b32 s13, s13, 10
  s_add_u32 s13, s13, 0xc00000
  buffer_store_dwordx4 v[64:67], v2, s[20:23], s13 offen sc1
  v_rcp_f32 v5, v216
  s_lshl_b32 s13, s28, 5
  v_mul_f32 v208, v208, v5
  v_mul_f32 v209, v209, v5
  v_mul_f32 v210, v210, v5
  v_mul_f32 v211, v211, v5
  v_mul_f32 v212, v212, v5
  v_mul_f32 v213, v213, v5
  v_mul_f32 v214, v214, v5
  v_mul_f32 v215, v215, v5
  v_cvt_pk_bf16_f32 v68, v208, v209
  v_cvt_pk_bf16_f32 v69, v210, v211
  v_cvt_pk_bf16_f32 v70, v212, v213
  v_cvt_pk_bf16_f32 v71, v214, v215
  s_add_u32 s13, s13, s6
  s_lshl_b32 s13, s13, 10
  s_add_u32 s13, s13, 0xc00000
  buffer_store_dwordx4 v[68:71], v2, s[20:23], s13 offen sc1
  s_setprio 0
  s_waitcnt vmcnt(2)
  s_mov_b32 exec_hi, 0
  v_cmp_ne_u32 vcc, s62, v170
  v_cmp_ne_u32 s[60:61], s63, v171
  s_mov_b64 exec, -1
  s_nop 3
  s_or_b64 vcc, vcc, s[60:61]
  s_cbranch_vccz P3A
  s_mov_b64 exec, 0xffffffff
  s_mov_b32 s57, 0x40000
F3A_POLL:
  global_load_dwordx2 v[170:171], v168, s[48:49] sc1
  s_waitcnt vmcnt(0)
  v_cmp_ne_u32 vcc, s62, v170
  v_cmp_ne_u32 s[60:61], s63, v171
  s_nop 4
  s_or_b64 vcc, vcc, s[60:61]
  s_cbranch_vccz F3A_POLLED
  s_sleep 8
  s_sub_u32 s57, s57, 1
  s_cmp_lg_u32 s57, 0
  s_cbranch_scc1 F3A_POLL
F3A_POLLED:
  s_mov_b64 exec, -1
  s_branch P3A
A_HOOK:
  s_barrier
  s_branch A_NEXT
A_HOOKM:
  s_waitcnt vmcnt(0)
  s_barrier
  s_branch A_MID
LAG:
  s_setprio 0
  v_mov_b32 v169, 0
  global_load_dwordx2 v[170:171], v169, s[46:47] sc1
  v_mul_f32 v80, s56, v80
  v_mul_f32 v81, s56, v81
  v_mul_f32 v82, s56, v82
  v_mul_f32 v83, s56, v83
  v_mul_f32 v84, s56, v84
  v_mul_f32 v85, s56, v85
  v_mul_f32 v86, s56, v86
  v_mul_f32 v87, s56, v87
  v_mul_f32 v88, s56, v88
  v_mul_f32 v89, s56, v89
  v_mul_f32 v90, s56, v90
  v_mul_f32 v91, s56, v91
  v_mul_f32 v92, s56, v92
  v_mul_f32 v93, s56, v93
  v_mul_f32 v94, s56, v94
  v_mul_f32 v95, s56, v95
  v_cvt_pk_bf16_f32 v24, v80, v81
  v_cvt_pk_bf16_f32 v25, v82, v83
  v_cvt_pk_bf16_f32 v26, v84, v85
  v_cvt_pk_bf16_f32 v27, v86, v87
  v_cvt_pk_bf16_f32 v28, v88, v89
  v_cvt_pk_bf16_f32 v29, v90, v91
  v_cvt_pk_bf16_f32 v30, v92, v93
  v_cvt_pk_bf16_f32 v31, v94, v95
  s_add_u32 s58, s54, 2097152
  buffer_store_dwordx4 v[24:27], v17, s[20:23], s58 offen sc1
  s_add_u32 s58, s54, 2162688
  buffer_store_dwordx4 v[28:31], v17, s[20:23], s58 offen sc1
  s_nop 0
  v_cvt_pk_bf16_f32 v24, v192, v193
  v_cvt_pk_bf16_f32 v25, v194, v195
  v_cvt_pk_bf16_f32 v26, v196, v197
  v_cvt_pk_bf16_f32 v27, v198, v199
  v_cvt_pk_bf16_f32 v28, v200, v201
  v_cvt_pk_bf16_f32 v29, v202, v203
  v_cvt_pk_bf16_f32 v30, v204, v205
  v_cvt_pk_bf16_f32 v31, v206, v207
  s_add_u32 s58, s55, 4194304
  buffer_store_dwordx4 v[24:27], v17, s[20:23], s58 offen sc1
  s_add_u32 s58, s55, 4325376
  buffer_store_dwordx4 v[28:31], v17, s[20:23], s58 offen sc1
  s_nop 0
  v_cvt_pk_bf16_f32 v24, v208, v209
  v_cvt_pk_bf16_f32 v25, v210, v211
  v_cvt_pk_bf16_f32 v26, v212, v213
  v_cvt_pk_bf16_f32 v27, v214, v215
  v_cvt_pk_bf16_f32 v28, v216, v217
  v_cvt_pk_bf16_f32 v29, v218, v219
  v_cvt_pk_bf16_f32 v30, v220, v221
  v_cvt_pk_bf16_f32 v31, v222, v223
  s_add_u32 s58, s55, 4194304
  buffer_store_dwordx4 v[24:27], v18, s[20:23], s58 offen sc1
  buffer_store_dwordx4 v[28:31], v18, s[20:23], s58 offen offset:512 sc1
  s_lshl_b32 s30, s11, 11
  s_mov_b32 s50, 0
DR_LOOP:
  s_add_u32 s31, s30, s9
  s_add_u32 s31, s31, 0x8000
  s_mov_b32 m0, s30
  s_add_u32 s58, s31, 1024
  buffer_load_dwordx4 v2, s[20:23], s31 offen sc1 lds
  s_add_u32 m0, s30, 1024
  s_add_u32 s30, s30, 0x2000
  buffer_load_dwordx4 v2, s[20:23], s58 offen sc1 lds
  s_add_u32 s50, s50, 1
  s_cmp_lt_u32 s50, 12
  s_cbranch_scc1 DR_LOOP
  v_mov_b32 v240, -1
  v_mov_b32 v241, -1
  v_mov_b32 v242, -1
  v_mov_b32 v243, -1
  s_lshl_b32 s13, s27, 5
  s_add_u32 s13, s13, s6
  s_lshl_b32 s13, s13, 10
  s_add_u32 s13, s13, 0xe00000
  buffer_store_dwordx4 v[240:243], v2, s[20:23], s13 offen sc1
  s_add_u32 s13, s13, 0x8000
  buffer_store_dwordx4 v[240:243], v2, s[20:23], s13 offen sc1
  v_and_b32 v28, 27, v1
  v_cmp_eq_u32 vcc, 16, v28
  v_mov_b32 v29, 0x3f803f80
  s_nop 1
  v_cndmask_b32 v176, 0, v29, vcc
  v_mov_b32 v177, v176
  v_mov_b32 v178, v176
  v_mov_b32 v179, v176
  v_mov_b32 v180, v176
  v_mov_b32 v181, v176
  v_mov_b32 v182, v176
  v_mov_b32 v183, v176
  v_mov_b32 v184, v176
  v_mov_b32 v185, v176
  v_mov_b32 v186, v176
  v_mov_b32 v187, v176
  v_mov_b32 v188, v176
  v_mov_b32 v189, v176
  v_mov_b32 v190, v176
  v_mov_b32 v191, v176
  v_mov_b32 v192, 0
  v_mov_b32 v193, 0
  v_mov_b32 v194, 0
  v_mov_b32 v195, 0
  v_mov_b32 v196, 0
  v_mov_b32 v197, 0
  v_mov_b32 v198, 0
  v_mov_b32 v199, 0
  v_mov_b32 v200, 0
  v_mov_b32 v201, 0
  v_mov_b32 v202, 0
  v_mov_b32 v203, 0
  v_mov_b32 v204, 0
  v_mov_b32 v205, 0
  v_mov_b32 v206, 0
  v_mov_b32 v207, 0
  v_mov_b32 v208, 0
  v_mov_b32 v209, 0
  v_mov_b32 v210, 0
  v_mov_b32 v211, 0
  v_mov_b32 v212, 0
  v_mov_b32 v213, 0
  v_mov_b32 v214, 0
  v_mov_b32 v215, 0
  v_mov_b32 v216, 0
  v_mov_b32 v217, 0
  v_mov_b32 v218, 0
  v_mov_b32 v219, 0
  v_mov_b32 v220, 0
  v_mov_b32 v221, 0
  v_mov_b32 v222, 0
  v_mov_b32 v223, 0
  v_mov_b32 v236, 0
  v_mov_b32 v237, 0
  v_mov_b32 v238, 0
  v_mov_b32 v239, 0
  s_waitcnt vmcnt(0)
  v_readfirstlane_b32 s62, v170
  v_readfirstlane_b32 s63, v171
  s_barrier
  s_cmp_lg_u32 s3, 0
  s_cbranch_scc1 LG_NOFLAG
  s_and_b32 s50, s4, 3
  s_lshl_b32 s50, s50, 3
  s_and_b32 s52, s5, 7
  s_add_u32 s50, s50, s52
  s_lshr_b32 s52, s5, 3
  s_lshl_b32 s52, s52, 1
  s_lshr_b32 s53, s4, 2
  s_xor_b32 s53, s53, 1
  s_add_u32 s52, s52, s53
  s_add_u32 s52, s52, 8
  s_mul_i32 s52, s52, 4096
  s_lshl_b32 s50, s50, 3
  s_add_u32 s52, s52, s50
  s_add_u32 s52, s52, 0x1800000
  v_mov_b32 v164, s52
  v_mov_b32 v162, s62
  v_mov_b32 v163, s63
  s_mov_b64 exec, 1
  global_store_dwordx2 v164, v[162:163], s[48:49] sc1
  s_mov_b64 exec, -1
  s_mul_i32 s52, s7, 4096
  s_lshl_b32 s53, s6, 3
  s_add_u32 s52, s52, s53
  s_add_u32 s52, s52, 0x1830000
  v_mov_b32 v164, s52
  v_mov_b32 v162, s62
  v_mov_b32 v163, s63
  s_mov_b64 exec, 1
  global_store_dwordx2 v164, v[162:163], s[48:49] sc1
  s_mov_b64 exec, -1
LG_NOFLAG:
  s_lshl_b32 s50, s5, 4
  s_lshl_b32 s52, s11, 2
  s_add_u32 s50, s50, s52
  s_lshl_b32 s50, s50, 10
  buffer_load_dwordx4 v[240:243], v2, s[80:83], s50 offen offset:0
  buffer_load_dwordx4 v[240:243], v2, s[80:83], s50 offen offset:1024
  buffer_load_dwordx4 v[240:243], v2, s[80:83], s50 offen offset:2048
  buffer_load_dwordx4 v[240:243], v2, s[80:83], s50 offen offset:3072
  buffer_load_dwordx4 v[240:243], v2, s[84:87], s50 offen offset:0
  buffer_load_dwordx4 v[240:243], v2, s[84:87], s50 offen offset:1024
  buffer_load_dwordx4 v[240:243], v2, s[84:87], s50 offen offset:2048
  buffer_load_dwordx4 v[240:243], v2, s[84:87], s50 offen offset:3072
  s_cmp_lg_u32 s3, 1
  s_cbranch_scc1 LG_WARM2
  v_lshlrev_b32 v162, 21, v1
  s_mov_b64 exec, 3
  global_load_dword v240, v162, s[44:45]
  s_mov_b64 exec, -1
LG_WARM2:
  s_lshr_b32 s50, s6, 2
  s_add_u32 s50, s50, 8
  s_mul_i32 s50, s50, 4096
  s_add_u32 s50, s50, 0x1800000
  v_lshlrev_b32 v162, 3, v1
  v_add_u32 v162, s50, v162
  s_mov_b64 exec, 0xffffffff
  s_mov_b32 s57, 0x40000
S1B_POLL:
  global_load_dwordx2 v[164:165], v162, s[48:49] sc1
  s_waitcnt vmcnt(0)
  v_cmp_ne_u32 vcc, s62, v164
  v_cmp_ne_u32 s[60:61], s63, v165
  s_nop 4
  s_or_b64 vcc, vcc, s[60:61]
  s_cbranch_vccz S1B_POLLED
  s_sleep 8
  s_sub_u32 s57, s57, 1
  s_cmp_lg_u32 s57, 0
  s_cbranch_scc1 S1B_POLL
S1B_POLLED:
  s_mov_b64 exec, -1
  s_lshl_b32 s50, s6, 17
  s_add_u32 s50, s50, 0x800000
  s_lshl_b32 s52, s7, 14
  s_add_u32 s50, s50, s52
  s_sub_u32 s50, s50, 0x4000
  s_lshl_b32 s53, s11, 13
  s_add_u32 s50, s50, s53
  s_cmp_eq_u32 s7, 0
  s_cselect_b32 s52, 1, 0
  s_cmp_lt_u32 s11, 2
  s_cselect_b32 s58, s52, 0
  s_cmp_eq_u32 s58, 1
  s_cselect_b32 s50, 0x7ff00000, s50
  s_add_u32 s53, s53, 0x18000
  s_add_u32 m0, s53, 0
  s_add_u32 s58, s50, 0
  buffer_load_dwordx4 v2, s[20:23], s58 offen sc1 lds
  s_add_u32 m0, s53, 1024
  s_add_u32 s58, s50, 1024
  buffer_load_dwordx4 v2, s[20:23], s58 offen sc1 lds
  s_add_u32 m0, s53, 2048
  s_add_u32 s58, s50, 2048
  buffer_load_dwordx4 v2, s[20:23], s58 offen sc1 lds
  s_add_u32 m0, s53, 3072
  s_add_u32 s58, s50, 3072
  buffer_load_dwordx4 v2, s[20:23], s58 offen sc1 lds
  s_add_u32 m0, s53, 4096
  s_add_u32 s58, s50, 4096
  buffer_load_dwordx4 v2, s[20:23], s58 offen sc1 lds
  s_add_u32 m0, s53, 5120
  s_add_u32 s58, s50, 5120
  buffer_load_dwordx4 v2, s[20:23], s58 offen sc1 lds
  s_add_u32 m0, s53, 6144
  s_add_u32 s58, s50, 6144
  buffer_load_dwordx4 v2, s[20:23], s58 offen sc1 lds
  s_add_u32 m0, s53, 7168
  s_add_u32 s58, s50, 7168
  buffer_load_dwordx4 v2, s[20:23], s58 offen sc1 lds
  s_add_u32 s15, s14, s27
  s_lshl_b32 s15, s15, 10
  s_add_u32 s15, s15, 0x200000
  buffer_load_dwordx4 v[60:63], v2, s[20:23], s15 offen sc1
  buffer_load_dwordx4 v[8:11], v2, s[20:23], s15 offen offset:1024 sc1
  s_waitcnt vmcnt(0)
  s_barrier
  s_setprio 2
  s_mov_b32 s8, s27
B_START:
  s_lshl_b32 s18, s7, 3
  s_sub_u32 s18, s8, s18
  s_lshl_b32 s18, s18, 11
  s_add_u32 s18, s18, 0x18000
  v_add_u32 v6, s18, v2
  v_add_u32 v7, s18, v3
  ds_read_b128 v[20:23], v6 offset:16384
  ds_read_b128 v[24:27], v6 offset:14336
  s_mov_b64 exec, s[16:17]
  ds_read_b128 v[176:179], v7 offset:16384
  ds_read_b128 v[180:183], v7 offset:16896
  s_mov_b64 exec, -1
  s_cmp_eq_u32 s7, 0
  s_cselect_b32 s15, s8, 8
  s_waitcnt lgkmcnt(2)
  v_mfma_f32_32x32x16_bf16 v[64:79], v[20:23], v[60:63], v[112:127]
  v_mfma_f32_32x32x16_bf16 v[80:95], v[24:27], v[60:63], 0
  v_mov_b32 v28, 0
  v_mov_b32 v29, 0
  v_mov_b32 v30, 0
  v_mov_b32 v31, 0
  v_mov_b32 v32, 0
  v_mov_b32 v33, 0
  v_mov_b32 v34, 0
  v_mov_b32 v35, 0
  v_mov_b32 v36, 0
  v_mov_b32 v37, 0
  v_mov_b32 v38, 0
  v_mov_b32 v39, 0
  v_max3_f32 v4, v64, v65, v66
  v_max3_f32 v4, v4, v67, v68
  v_max3_f32 v4, v4, v69, v70
  v_max3_f32 v4, v4, v71, v72
  v_max3_f32 v4, v4, v73, v74
  v_max3_f32 v4, v4, v75, v76
  v_max3_f32 v4, v4, v77, v78
  v_max_f32 v4, v4, v79
  s_cmp_eq_u32 s8, 0
  s_cbranch_scc1 B_NOPREV
  v_max3_f32 v4, v4, v80, v81
  v_max3_f32 v4, v4, v82, v83
  v_max3_f32 v4, v4, v84, v85
  v_max3_f32 v4, v4, v86, v87
  v_max3_f32 v4, v4, v88, v89
  v_max3_f32 v4, v4, v90, v91
  v_max3_f32 v4, v4, v92, v93
  v_max3_f32 v4, v4, v94, v95
B_NOPREV:
  v_mov_b32 v5, v4
  s_nop 1
  v_permlane32_swap_b32 v4, v5
  s_nop 1
  v_max_f32 v4, v4, v5
  v_sub_f32 v44, 0, v4
  v_sub_f32 v45, 0, v4
  v_sub_f32 v46, 0, v4
  v_sub_f32 v47, 0, v4
  v_sub_f32 v48, 0, v4
  v_sub_f32 v49, 0, v4
  v_sub_f32 v50, 0, v4
  v_sub_f32 v51, 0, v4
  v_sub_f32 v52, 0, v4
  v_sub_f32 v53, 0, v4
  v_sub_f32 v54, 0, v4
  v_sub_f32 v55, 0, v4
  v_sub_f32 v56, 0, v4
  v_sub_f32 v57, 0, v4
  v_sub_f32 v58, 0, v4
  v_sub_f32 v59, 0, v4
  s_nop 1
  v_mfma_f32_32x32x16_bf16 v[64:79], v[20:23], v[60:63], v[44:59]
  v_mov_b32 v40, 0
  v_mov_b32 v41, 0
  v_mov_b32 v42, 0
  v_mov_b32 v43, 0
  v_mov_b32 v236, 0
  v_mov_b32 v237, 0
  v_mov_b32 v238, 0
  v_mov_b32 v239, 0
  s_nop 3
  v_mfma_f32_32x32x16_bf16 v[80:95], v[24:27], v[60:63], v[44:59]
  ds_read_b128 v[20:23], v6 offset:12288
  v_exp_f32 v64, v64
  v_exp_f32 v65, v65
  v_exp_f32 v66, v66
  v_exp_f32 v67, v67
  v_cvt_pk_bf16_f32 v224, v64, v65
  v_and_b32 v224, v224, v96
  v_mfma_f32_32x32x16_bf16 v[28:43], v[188:191], v[236:239], v[28:43]
  s_mov_b64 exec, s[16:17]
  ds_read_b128 v[184:187], v7 offset:14336
  ds_read_b128 v[188:191], v7 offset:14848
  s_mov_b64 exec, -1
  v_exp_f32 v68, v68
  v_exp_f32 v69, v69
  v_cvt_pk_bf16_f32 v225, v66, v67
  v_and_b32 v225, v225, v97
  v_exp_f32 v70, v70
  v_exp_f32 v71, v71
  v_cvt_pk_bf16_f32 v226, v68, v69
  v_and_b32 v226, v226, v98
  v_exp_f32 v72, v72
  v_exp_f32 v73, v73
  v_cvt_pk_bf16_f32 v227, v70, v71
  v_and_b32 v227, v227, v99
  v_exp_f32 v74, v74
  v_exp_f32 v75, v75
  v_cvt_pk_bf16_f32 v228, v72, v73
  v_and_b32 v228, v228, v100
  s_waitcnt lgkmcnt(3)
  v_mfma_f32_32x32x16_bf16 v[28:43], v[176:179], v[224:227], v[28:43]
  v_exp_f32 v76, v76
  v_exp_f32 v77, v77
  v_cvt_pk_bf16_f32 v229, v74, v75
  v_and_b32 v229, v229, v101
  v_exp_f32 v78, v78
  v_exp_f32 v79, v79
  v_cvt_pk_bf16_f32 v230, v76, v77
  v_and_b32 v230, v230, v102
  v_cvt_pk_bf16_f32 v231, v78, v79
  v_and_b32 v231, v231, v103
  s_cmp_eq_u32 s15, 0
  s_cbranch_scc1 B_EXIT0
  s_waitcnt lgkmcnt(2)
  v_mfma_f32_32x32x16_bf16 v[64:79], v[20:23], v[60:63], v[44:59]
  ds_read_b128 v[24:27], v6 offset:10240
  v_exp_f32 v80, v80
  v_exp_f32 v81, v81
  v_exp_f32 v82, v82
  v_exp_f32 v83, v83
  v_cvt_pk_bf16_f32 v232, v80, v81
  v_mfma_f32_32x32x16_bf16 v[28:43], v[180:183], v[228:231], v[28:43]
  s_mov_b64 exec, s[16:17]
  ds_read_b128 v[176:179], v7 offset:12288
  ds_read_b128 v[180:183], v7 offset:12800
  s_mov_b64 exec, -1
  v_exp_f32 v84, v84
  v_exp_f32 v85, v85
  v_cvt_pk_bf16_f32 v233, v82, v83
  v_exp_f32 v86, v86
  v_exp_f32 v87, v87
  v_cvt_pk_bf16_f32 v234, v84, v85
  v_exp_f32 v88, v88
  v_exp_f32 v89, v89
  v_cvt_pk_bf16_f32 v235, v86, v87
  v_exp_f32 v90, v90
  v_exp_f32 v91, v91
  v_cvt_pk_bf16_f32 v236, v88, v89
  s_waitcnt lgkmcnt(3)
  v_mfma_f32_32x32x16_bf16 v[28:43], v[184:187], v[232:235], v[28:43]
  v_exp_f32 v92, v92
  v_exp_f32 v93, v93
  v_cvt_pk_bf16_f32 v237, v90, v91
  v_exp_f32 v94, v94
  v_exp_f32 v95, v95
  v_cvt_pk_bf16_f32 v238, v92, v93
  v_cvt_pk_bf16_f32 v239, v94, v95
  s_cmp_eq_u32 s15, 1
  s_cbranch_scc1 B_EXIT1
  s_waitcnt lgkmcnt(2)
  v_mfma_f32_32x32x16_bf16 v[80:95], v[24:27], v[60:63], v[44:59]
  ds_read_b128 v[20:23], v6 offset:8192
  v_exp_f32 v64, v64
  v_exp_f32 v65, v65
  v_exp_f32 v66, v66
  v_exp_f32 v67, v67
  v_cvt_pk_bf16_f32 v224, v64, v65
  v_mfma_f32_32x32x16_bf16 v[28:43], v[188:191], v[236:239], v[28:43]
  s_mov_b64 exec, s[16:17]
  ds_read_b128 v[184:187], v7 offset:10240
  ds_read_b128 v[188:191], v7 offset:10752
  s_mov_b64 exec, -1
  v_exp_f32 v68, v68
  v_exp_f32 v69, v69
  v_cvt_pk_bf16_f32 v225, v66, v67
  v_exp_f32 v70, v70
  v_exp_f32 v71, v71
  v_cvt_pk_bf16_f32 v226, v68, v69
  v_exp_f32 v72, v72
  v_exp_f32 v73, v73
  v_cvt_pk_bf16_f32 v227, v70, v71
  v_exp_f32 v74, v74
  v_exp_f32 v75, v75
  v_cvt_pk_bf16_f32 v228, v72, v73
  s_waitcnt lgkmcnt(3)
  v_mfma_f32_32x32x16_bf16 v[28:43], v[176:179], v[224:227], v[28:43]
  v_exp_f32 v76, v76
  v_exp_f32 v77, v77
  v_cvt_pk_bf16_f32 v229, v74, v75
  v_exp_f32 v78, v78
  v_exp_f32 v79, v79
  v_cvt_pk_bf16_f32 v230, v76, v77
  v_cvt_pk_bf16_f32 v231, v78, v79
  s_cmp_eq_u32 s15, 2
  s_cbranch_scc1 B_EXIT0
  s_waitcnt lgkmcnt(2)
  v_mfma_f32_32x32x16_bf16 v[64:79], v[20:23], v[60:63], v[44:59]
  ds_read_b128 v[24:27], v6 offset:6144
  v_exp_f32 v80, v80
  v_exp_f32 v81, v81
  v_exp_f32 v82, v82
  v_exp_f32 v83, v83
  v_cvt_pk_bf16_f32 v232, v80, v81
  v_mfma_f32_32x32x16_bf16 v[28:43], v[180:183], v[228:231], v[28:43]
  s_mov_b64 exec, s[16:17]
  ds_read_b128 v[176:179], v7 offset:8192
  ds_read_b128 v[180:183], v7 offset:8704
  s_mov_b64 exec, -1
  v_exp_f32 v84, v84
  v_exp_f32 v85, v85
  v_cvt_pk_bf16_f32 v233, v82, v83
  v_exp_f32 v86, v86
  v_exp_f32 v87, v87
  v_cvt_pk_bf16_f32 v234, v84, v85
  v_exp_f32 v88, v88
  v_exp_f32 v89, v89
  v_cvt_pk_bf16_f32 v235, v86, v87
  v_exp_f32 v90, v90
  v_exp_f32 v91, v91
  v_cvt_pk_bf16_f32 v236, v88, v89
  s_waitcnt lgkmcnt(3)
  v_mfma_f32_32x32x16_bf16 v[28:43], v[184:187], v[232:235], v[28:43]
  v_exp_f32 v92, v92
  v_exp_f32 v93, v93
  v_cvt_pk_bf16_f32 v237, v90, v91
  v_exp_f32 v94, v94
  v_exp_f32 v95, v95
  v_cvt_pk_bf16_f32 v238, v92, v93
  v_cvt_pk_bf16_f32 v239, v94, v95
  s_cmp_eq_u32 s15, 3
  s_cbranch_scc1 B_EXIT1
  s_waitcnt lgkmcnt(2)
  v_mfma_f32_32x32x16_bf16 v[80:95], v[24:27], v[60:63], v[44:59]
  ds_read_b128 v[20:23], v6 offset:4096
  v_exp_f32 v64, v64
  v_exp_f32 v65, v65
  v_exp_f32 v66, v66
  v_exp_f32 v67, v67
  v_cvt_pk_bf16_f32 v224, v64, v65
  v_mfma_f32_32x32x16_bf16 v[28:43], v[188:191], v[236:239], v[28:43]
  s_mov_b64 exec, s[16:17]
  ds_read_b128 v[184:187], v7 offset:6144
  ds_read_b128 v[188:191], v7 offset:6656
  s_mov_b64 exec, -1
  v_exp_f32 v68, v68
  v_exp_f32 v69, v69
  v_cvt_pk_bf16_f32 v225, v66, v67
  v_exp_f32 v70, v70
  v_exp_f32 v71, v71
  v_cvt_pk_bf16_f32 v226, v68, v69
  v_exp_f32 v72, v72
  v_exp_f32 v73, v73
  v_cvt_pk_bf16_f32 v227, v70, v71
  v_exp_f32 v74, v74
  v_exp_f32 v75, v75
  v_cvt_pk_bf16_f32 v228, v72, v73
  s_waitcnt lgkmcnt(3)
  v_mfma_f32_32x32x16_bf16 v[28:43], v[176:179], v[224:227], v[28:43]
  v_exp_f32 v76, v76
  v_exp_f32 v77, v77
  v_cvt_pk_bf16_f32 v229, v74, v75
  v_exp_f32 v78, v78
  v_exp_f32 v79, v79
  v_cvt_pk_bf16_f32 v230, v76, v77
  v_cvt_pk_bf16_f32 v231, v78, v79
  s_cmp_eq_u32 s15, 4
  s_cbranch_scc1 B_EXIT0
  s_waitcnt lgkmcnt(2)
  v_mfma_f32_32x32x16_bf16 v[64:79], v[20:23], v[60:63], v[44:59]
  ds_read_b128 v[24:27], v6 offset:2048
  v_exp_f32 v80, v80
  v_exp_f32 v81, v81
  v_exp_f32 v82, v82
  v_exp_f32 v83, v83
  v_cvt_pk_bf16_f32 v232, v80, v81
  v_mfma_f32_32x32x16_bf16 v[28:43], v[180:183], v[228:231], v[28:43]
  s_mov_b64 exec, s[16:17]
  ds_read_b128 v[176:179], v7 offset:4096
  ds_read_b128 v[180:183], v7 offset:4608
  s_mov_b64 exec, -1
  v_exp_f32 v84, v84
  v_exp_f32 v85, v85
  v_cvt_pk_bf16_f32 v233, v82, v83
  v_exp_f32 v86, v86
  v_exp_f32 v87, v87
  v_cvt_pk_bf16_f32 v234, v84, v85
  v_exp_f32 v88, v88
  v_exp_f32 v89, v89
  v_cvt_pk_bf16_f32 v235, v86, v87
  v_exp_f32 v90, v90
  v_exp_f32 v91, v91
  v_cvt_pk_bf16_f32 v236, v88, v89
  s_waitcnt lgkmcnt(3)
  v_mfma_f32_32x32x16_bf16 v[28:43], v[184:187], v[232:235], v[28:43]
  v_exp_f32 v92, v92
  v_exp_f32 v93, v93
  v_cvt_pk_bf16_f32 v237, v90, v91
  v_exp_f32 v94, v94
  v_exp_f32 v95, v95
  v_cvt_pk_bf16_f32 v238, v92, v93
  v_cvt_pk_bf16_f32 v239, v94, v95
  s_cmp_eq_u32 s15, 5
  s_cbranch_scc1 B_EXIT1
  s_waitcnt lgkmcnt(2)
  v_mfma_f32_32x32x16_bf16 v[80:95], v[24:27], v[60:63], v[44:59]
  ds_read_b128 v[20:23], v6 offset:0
  v_exp_f32 v64, v64
  v_exp_f32 v65, v65
  v_exp_f32 v66, v66
  v_exp_f32 v67, v67
  v_cvt_pk_bf16_f32 v224, v64, v65
  v_mfma_f32_32x32x16_bf16 v[28:43], v[188:191], v[236:239], v[28:43]
  s_mov_b64 exec, s[16:17]
  ds_read_b128 v[184:187], v7 offset:2048
  ds_read_b128 v[188:191], v7 offset:2560
  s_mov_b64 exec, -1
  v_exp_f32 v68, v68
  v_exp_f32 v69, v69
  v_cvt_pk_bf16_f32 v225, v66, v67
  v_exp_f32 v70, v70
  v_exp_f32 v71, v71
  v_cvt_pk_bf16_f32 v226, v68, v69
  v_exp_f32 v72, v72
  v_exp_f32 v73, v73
  v_cvt_pk_bf16_f32 v227, v70, v71
  v_exp_f32 v74, v74
  v_exp_f32 v75, v75
  v_cvt_pk_bf16_f32 v228, v72, v73
  s_waitcnt lgkmcnt(3)
  v_mfma_f32_32x32x16_bf16 v[28:43], v[176:179], v[224:227], v[28:43]
  v_exp_f32 v76, v76
  v_exp_f32 v77, v77
  v_cvt_pk_bf16_f32 v229, v74, v75
  v_exp_f32 v78, v78
  v_exp_f32 v79, v79
  v_cvt_pk_bf16_f32 v230, v76, v77
  v_cvt_pk_bf16_f32 v231, v78, v79
  s_cmp_eq_u32 s15, 6
  s_cbranch_scc1 B_EXIT0
  s_waitcnt lgkmcnt(2)
  v_mfma_f32_32x32x16_bf16 v[64:79], v[20:23], v[60:63], v[44:59]
  v_exp_f32 v80, v80
  v_exp_f32 v81, v81
  v_exp_f32 v82, v82
  v_exp_f32 v83, v83
  v_cvt_pk_bf16_f32 v232, v80, v81
  v_mfma_f32_32x32x16_bf16 v[28:43], v[180:183], v[228:231], v[28:43]
  s_mov_b64 exec, s[16:17]
  ds_read_b128 v[176:179], v7 offset:0
  ds_read_b128 v[180:183], v7 offset:512
  s_mov_b64 exec, -1
  v_exp_f32 v84, v84
  v_exp_f32 v85, v85
  v_cvt_pk_bf16_f32 v233, v82, v83
  v_exp_f32 v86, v86
  v_exp_f32 v87, v87
  v_cvt_pk_bf16_f32 v234, v84, v85
  v_exp_f32 v88, v88
  v_exp_f32 v89, v89
  v_cvt_pk_bf16_f32 v235, v86, v87
  v_exp_f32 v90, v90
  v_exp_f32 v91, v91
  v_cvt_pk_bf16_f32 v236, v88, v89
  s_waitcnt lgkmcnt(2)
  v_mfma_f32_32x32x16_bf16 v[28:43], v[184:187], v[232:235], v[28:43]
  v_exp_f32 v92, v92
  v_exp_f32 v93, v93
  v_cvt_pk_bf16_f32 v237, v90, v91
  v_exp_f32 v94, v94
  v_exp_f32 v95, v95
  v_cvt_pk_bf16_f32 v238, v92, v93
  v_cvt_pk_bf16_f32 v239, v94, v95
  s_cmp_eq_u32 s15, 7
  s_cbranch_scc1 B_EXIT1
  v_exp_f32 v64, v64
  v_exp_f32 v65, v65
  v_exp_f32 v66, v66
  v_exp_f32 v67, v67
  v_cvt_pk_bf16_f32 v224, v64, v65
  v_and_b32 v224, v224, v104
  v_mfma_f32_32x32x16_bf16 v[28:43], v[188:191], v[236:239], v[28:43]
  v_exp_f32 v68, v68
  v_exp_f32 v69, v69
  v_cvt_pk_bf16_f32 v225, v66, v67
  v_and_b32 v225, v225, v105
  v_exp_f32 v70, v70
  v_exp_f32 v71, v71
  v_cvt_pk_bf16_f32 v226, v68, v69
  v_and_b32 v226, v226, v106
  v_exp_f32 v72, v72
  v_exp_f32 v73, v73
  v_cvt_pk_bf16_f32 v227, v70, v71
  v_and_b32 v227, v227, v107
  v_exp_f32 v74, v74
  v_exp_f32 v75, v75
  v_cvt_pk_bf16_f32 v228, v72, v73
  v_and_b32 v228, v228, v108
  s_waitcnt lgkmcnt(0)
  v_mfma_f32_32x32x16_bf16 v[28:43], v[176:179], v[224:227], v[28:43]
  v_exp_f32 v76, v76
  v_exp_f32 v77, v77
  v_cvt_pk_bf16_f32 v229, v74, v75
  v_and_b32 v229, v229, v109
  v_exp_f32 v78, v78
  v_exp_f32 v79, v79
  v_cvt_pk_bf16_f32 v230, v76, v77
  v_and_b32 v230, v230, v110
  v_cvt_pk_bf16_f32 v231, v78, v79
  v_and_b32 v231, v231, v111
B_EXIT0:
  s_nop 1
  v_mfma_f32_32x32x16_bf16 v[28:43], v[180:183], v[228:231], v[28:43]
B_TAIL:
  s_waitcnt lgkmcnt(0)
  s_nop 15
  v_max3_f32 v4, |v28|, |v29|, |v30|
  v_max3_f32 v4, v4, |v31|, |v32|
  v_max3_f32 v4, v4, |v33|, |v34|
  v_max3_f32 v4, v4, |v35|, |v36|
  v_add_f32 v5, v28, v29
  v_add_f32 v5, v5, v30
  v_add_f32 v5, v5, v31
  v_add_f32 v5, v5, v32
  v_add_f32 v5, v5, v33
  v_add_f32 v5, v5, v34
  v_add_f32 v5, v5, v35
  v_add_f32 v5, v5, v36
  v_and_b32 v5, 0x7fffffff, v5
  v_max_i32 v4, v4, v5
  s_mov_b32 s25, 0x7b800000
  v_cmp_gt_i32 vcc, s25, v4
  s_nop 4
  s_cmp_eq_u64 vcc, -1
  s_cselect_b32 s25, 0, 1
  s_cmp_lg_u32 s25, 0
  s_cbranch_scc1 B_SLOW
B_DONE:
  v_rcp_f32 v5, v36
  s_lshl_b32 s13, s8, 5
  v_mul_f32 v28, v28, v5
  v_mul_f32 v29, v29, v5
  v_mul_f32 v30, v30, v5
  v_mul_f32 v31, v31, v5
  v_mul_f32 v32, v32, v5
  v_mul_f32 v33, v33, v5
  v_mul_f32 v34, v34, v5
  v_mul_f32 v35, v35, v5
  v_cvt_pk_bf16_f32 v64, v28, v29
  v_cvt_pk_bf16_f32 v65, v30, v31
  v_cvt_pk_bf16_f32 v66, v32, v33
  v_cvt_pk_bf16_f32 v67, v34, v35
  s_add_u32 s13, s13, s6
  s_lshl_b32 s13, s13, 10
  s_add_u32 s13, s13, 0xe00000
  buffer_store_dwordx4 v[64:67], v2, s[20:23], s13 offen sc1
  s_cmp_eq_u32 s8, s28
  s_cbranch_scc1 B_END
  s_mov_b32 s8, s28
  v_mov_b32 v60, v8
  v_mov_b32 v61, v9
  v_mov_b32 v62, v10
  v_mov_b32 v63, v11
  s_branch B_START
B_END:
  s_setprio 0
  s_barrier
  v_lshrrev_b32 v8, 3, v1
  v_bfe_u32 v9, v1, 4, 1
  v_lshlrev_b32 v9, 2, v9
  v_and_b32 v10, 7, v1
  v_xor_b32 v10, v10, v9
  v_lshlrev_b32 v10, 4, v10
  v_lshlrev_b32 v8, 10, v8
  v_add_u32 v8, v8, v10
  s_lshl_b32 s30, s11, 17
  s_lshl_b32 s31, s65, 7
  s_add_u32 s30, s30, s31
  s_lshl_b32 s31, s11, 14
  s_add_u32 s73, s31, 0x20000
  s_add_u32 s51, s31, 0x10000
  s_cmp_lt_u32 s11, 2
  s_cselect_b32 s73, s73, s51
  s_mov_b32 s50, 0
WO_LOOP:
  s_lshl_b32 s51, s50, 10
  s_lshl_b32 s52, s50, 13
  s_add_u32 s52, s52, s30
  s_add_u32 m0, s73, s51
  s_nop 0
  buffer_load_dwordx4 v8, s[84:87], s52 offen lds
  s_add_u32 m0, s31, s51
  s_add_u32 s50, s50, 1
  buffer_load_dwordx4 v8, s[80:83], s52 offen lds
  s_cmp_lt_u32 s50, 16
  s_cbranch_scc1 WO_LOOP
  s_and_b32 s66, s11, 1
  s_lshr_b32 s67, s11, 1
  s_lshl_b32 s69, s64, 1
  s_add_u32 s69, s69, s66
  s_lshl_b32 s71, s69, 15
  s_add_u32 s71, s71, 0xe00000
  s_mov_b64 exec, 0xffffffff
  s_mov_b32 s57, 0x40000
F3B_POLL:
  global_load_dwordx2 v[170:171], v168, s[48:49] sc1
  s_waitcnt vmcnt(0)
  v_cmp_ne_u32 vcc, s62, v170
  v_cmp_ne_u32 s[60:61], s63, v171
  s_nop 4
  s_or_b64 vcc, vcc, s[60:61]
  s_cbranch_vccz F3B_POLLED
  s_sleep 8
  s_sub_u32 s57, s57, 1
  s_cmp_lg_u32 s57, 0
  s_cbranch_scc1 F3B_POLL
F3B_POLLED:
  s_mov_b64 exec, -1
  s_mov_b32 s50, s71
  buffer_load_dwordx4 v[128:131], v2, s[20:23], s50 offen offset:0 sc1
  buffer_load_dwordx4 v[132:135], v2, s[20:23], s50 offen offset:1024 sc1
  buffer_load_dwordx4 v[136:139], v2, s[20:23], s50 offen offset:2048 sc1
  buffer_load_dwordx4 v[140:143], v2, s[20:23], s50 offen offset:3072 sc1
  s_add_u32 s50, s50, 4096
  buffer_load_dwordx4 v[144:147], v2, s[20:23], s50 offen offset:0 sc1
  buffer_load_dwordx4 v[148:151], v2, s[20:23], s50 offen offset:1024 sc1
  buffer_load_dwordx4 v[152:155], v2, s[20:23], s50 offen offset:2048 sc1
  buffer_load_dwordx4 v[156:159], v2, s[20:23], s50 offen offset:3072 sc1
  s_add_u32 s50, s50, 4096
  buffer_load_dwordx4 v[160:163], v2, s[20:23], s50 offen offset:0 sc1
  buffer_load_dwordx4 v[164:167], v2, s[20:23], s50 offen offset:1024 sc1
  buffer_load_dwordx4 v[168:171], v2, s[20:23], s50 offen offset:2048 sc1
  buffer_load_dwordx4 v[172:175], v2, s[20:23], s50 offen offset:3072 sc1
  s_add_u32 s50, s50, 4096
  buffer_load_dwordx4 v[176:179], v2, s[20:23], s50 offen offset:0 sc1
  buffer_load_dwordx4 v[180:183], v2, s[20:23], s50 offen offset:1024 sc1
  buffer_load_dwordx4 v[184:187], v2, s[20:23], s50 offen offset:2048 sc1
  buffer_load_dwordx4 v[188:191], v2, s[20:23], s50 offen offset:3072 sc1
  v_and_b32 v4, 1, v1
  v_lshlrev_b32 v4, 2, v4
  v_bfe_u32 v5, v1, 1, 1
  v_or_b32 v4, v4, v5
  v_bfe_u32 v5, v1, 4, 1
  v_lshlrev_b32 v5, 1, v5
  v_or_b32 v4, v4, v5
  v_lshlrev_b32 v4, 3, v4
  v_bfe_u32 v5, v1, 3, 1
  v_lshlrev_b32 v5, 6, v5
  v_xor_b32 v4, v4, v5
  v_bfe_u32 v5, v1, 2, 2
  v_lshlrev_b32 v5, 7, v5
  v_add_u32 v4, v4, v5
  v_lshrrev_b32 v5, 5, v1
  v_lshlrev_b32 v5, 10, v5
  v_add_u32 v10, v4, v5
  s_lshl_b32 s50, s67, 6
  v_xor_b32 v10, s50, v10
  s_mov_b32 s57, 0x4000
OVB0_LOOP:
  s_waitcnt vmcnt(0)
  v_max3_u32 v4, v128, v129, v130
  v_max3_u32 v4, v4, v131, v132
  v_max3_u32 v4, v4, v133, v134
  v_max3_u32 v4, v4, v135, v136
  v_max3_u32 v4, v4, v137, v138
  v_max3_u32 v4, v4, v139, v140
  v_max3_u32 v4, v4, v141, v142
  v_max3_u32 v4, v4, v143, v144
  v_max3_u32 v4, v4, v145, v146
  v_max3_u32 v4, v4, v147, v148
  v_max3_u32 v4, v4, v149, v150
  v_max3_u32 v4, v4, v151, v152
  v_max3_u32 v4, v4, v153, v154
  v_max3_u32 v4, v4, v155, v156
  v_max3_u32 v4, v4, v157, v158
  v_max3_u32 v4, v4, v159, v160
  v_max3_u32 v4, v4, v161, v162
  v_max3_u32 v4, v4, v163, v164
  v_max3_u32 v4, v4, v165, v166
  v_max3_u32 v4, v4, v167, v168
  v_max3_u32 v4, v4, v169, v170
  v_max3_u32 v4, v4, v171, v172
  v_max3_u32 v4, v4, v173, v174
  v_max3_u32 v4, v4, v175, v176
  v_max3_u32 v4, v4, v177, v178
  v_max3_u32 v4, v4, v179, v180
  v_max3_u32 v4, v4, v181, v182
  v_max3_u32 v4, v4, v183, v184
  v_max3_u32 v4, v4, v185, v186
  v_max3_u32 v4, v4, v187, v188
  v_max3_u32 v4, v4, v189, v190
  v_max_u32 v4, v4, v191
  v_cmp_eq_u32 vcc, -1, v4
  s_nop 4
  s_cbranch_vccz OVB0_OK
  v_lshlrev_b32 v5, 10, v1
  s_add_u32 s50, s71, 1020
  s_mov_b64 exec, 0xffff
OVB0_CAN:
  buffer_load_dword v6, v5, s[20:23], s50 offen sc1
  s_waitcnt vmcnt(0)
  v_cmp_eq_u32 vcc, -1, v6
  s_sub_u32 s57, s57, 1
  s_nop 3
  s_cbranch_vccz OVB0_CANOK
  s_sleep 2
  s_cmp_gt_i32 s57, 0
  s_cbranch_scc1 OVB0_CAN
OVB0_CANOK:
  s_mov_b64 exec, -1
  s_mov_b32 s50, s71
  buffer_load_dwordx4 v[128:131], v2, s[20:23], s50 offen offset:0 sc1
  buffer_load_dwordx4 v[132:135], v2, s[20:23], s50 offen offset:1024 sc1
  buffer_load_dwordx4 v[136:139], v2, s[20:23], s50 offen offset:2048 sc1
  buffer_load_dwordx4 v[140:143], v2, s[20:23], s50 offen offset:3072 sc1
  s_add_u32 s50, s50, 4096
  buffer_load_dwordx4 v[144:147], v2, s[20:23], s50 offen offset:0 sc1
  buffer_load_dwordx4 v[148:151], v2, s[20:23], s50 offen offset:1024 sc1
  buffer_load_dwordx4 v[152:155], v2, s[20:23], s50 offen offset:2048 sc1
  buffer_load_dwordx4 v[156:159], v2, s[20:23], s50 offen offset:3072 sc1
  s_add_u32 s50, s50, 4096
  buffer_load_dwordx4 v[160:163], v2, s[20:23], s50 offen offset:0 sc1
  buffer_load_dwordx4 v[164:167], v2, s[20:23], s50 offen offset:1024 sc1
  buffer_load_dwordx4 v[168:171], v2, s[20:23], s50 offen offset:2048 sc1
  buffer_load_dwordx4 v[172:175], v2, s[20:23], s50 offen offset:3072 sc1
  s_add_u32 s50, s50, 4096
  buffer_load_dwordx4 v[176:179], v2, s[20:23], s50 offen offset:0 sc1
  buffer_load_dwordx4 v[180:183], v2, s[20:23], s50 offen offset:1024 sc1
  buffer_load_dwordx4 v[184:187], v2, s[20:23], s50 offen offset:2048 sc1
  buffer_load_dwordx4 v[188:191], v2, s[20:23], s50 offen offset:3072 sc1
  s_sub_u32 s57, s57, 1
  s_cmp_gt_i32 s57, 0
  s_cbranch_scc1 OVB0_LOOP
  s_waitcnt vmcnt(0)
OVB0_OK:
  s_barrier
  v_add_u32 v11, 0x20000, v10
  ds_read_b64_tr_b16 v[80:81], v11 offset:0
  ds_read_b64_tr_b16 v[82:83], v11 offset:512
  ds_read_b64_tr_b16 v[84:85], v11 offset:2048
  ds_read_b64_tr_b16 v[86:87], v11 offset:2560
  s_waitcnt lgkmcnt(2)
  v_mfma_f32_32x32x16_bf16 v[64:79], v[80:83], v[128:131], 0
  ds_read_b64_tr_b16 v[80:81], v11 offset:4096
  ds_read_b64_tr_b16 v[82:83], v11 offset:4608
  s_waitcnt lgkmcnt(2)
  v_mfma_f32_32x32x16_bf16 v[64:79], v[84:87], v[132:135], v[64:79]
  ds_read_b64_tr_b16 v[84:85], v11 offset:6144
  ds_read_b64_tr_b16 v[86:87], v11 offset:6656
  s_waitcnt lgkmcnt(2)
  v_mfma_f32_32x32x16_bf16 v[64:79], v[80:83], v[136:139], v[64:79]
  ds_read_b64_tr_b16 v[80:81], v11 offset:8192
  ds_read_b64_tr_b16 v[82:83], v11 offset:8704
  s_waitcnt lgkmcnt(2)
  v_mfma_f32_32x32x16_bf16 v[64:79], v[84:87], v[140:143], v[64:79]
  ds_read_b64_tr_b16 v[84:85], v11 offset:10240
  ds_read_b64_tr_b16 v[86:87], v11 offset:10752
  s_waitcnt lgkmcnt(2)
  v_mfma_f32_32x32x16_bf16 v[64:79], v[80:83], v[144:147], v[64:79]
  ds_read_b64_tr_b16 v[80:81], v11 offset:12288
  ds_read_b64_tr_b16 v[82:83], v11 offset:12800
  s_waitcnt lgkmcnt(2)
  v_mfma_f32_32x32x16_bf16 v[64:79], v[84:87], v[148:151], v[64:79]
  ds_read_b64_tr_b16 v[84:85], v11 offset:14336
  ds_read_b64_tr_b16 v[86:87], v11 offset:14848
  s_waitcnt lgkmcnt(2)
  v_mfma_f32_32x32x16_bf16 v[64:79], v[80:83], v[152:155], v[64:79]
  ds_read_b64_tr_b16 v[80:81], v11 offset:16384
  ds_read_b64_tr_b16 v[82:83], v11 offset:16896
  s_waitcnt lgkmcnt(2)
  v_mfma_f32_32x32x16_bf16 v[64:79], v[84:87], v[156:159], v[64:79]
  ds_read_b64_tr_b16 v[84:85], v11 offset:18432
  ds_read_b64_tr_b16 v[86:87], v11 offset:18944
  s_waitcnt lgkmcnt(2)
  v_mfma_f32_32x32x16_bf16 v[64:79], v[80:83], v[160:163], v[64:79]
  ds_read_b64_tr_b16 v[80:81], v11 offset:20480
  ds_read_b64_tr_b16 v[82:83], v11 offset:20992
  s_waitcnt lgkmcnt(2)
  v_mfma_f32_32x32x16_bf16 v[64:79], v[84:87], v[164:167], v[64:79]
  ds_read_b64_tr_b16 v[84:85], v11 offset:22528
  ds_read_b64_tr_b16 v[86:87], v11 offset:23040
  s_waitcnt lgkmcnt(2)
  v_mfma_f32_32x32x16_bf16 v[64:79], v[80:83], v[168:171], v[64:79]
  ds_read_b64_tr_b16 v[80:81], v11 offset:24576
  ds_read_b64_tr_b16 v[82:83], v11 offset:25088
  s_waitcnt lgkmcnt(2)
  v_mfma_f32_32x32x16_bf16 v[64:79], v[84:87], v[172:175], v[64:79]
  ds_read_b64_tr_b16 v[84:85], v11 offset:26624
  ds_read_b64_tr_b16 v[86:87], v11 offset:27136
  s_waitcnt lgkmcnt(2)
  v_mfma_f32_32x32x16_bf16 v[64:79], v[80:83], v[176:179], v[64:79]
  ds_read_b64_tr_b16 v[80:81], v11 offset:28672
  ds_read_b64_tr_b16 v[82:83], v11 offset:29184
  s_waitcnt lgkmcnt(2)
  v_mfma_f32_32x32x16_bf16 v[64:79], v[84:87], v[180:183], v[64:79]
  ds_read_b64_tr_b16 v[84:85], v11 offset:30720
  ds_read_b64_tr_b16 v[86:87], v11 offset:31232
  s_waitcnt lgkmcnt(2)
  v_mfma_f32_32x32x16_bf16 v[64:79], v[80:83], v[184:187], v[64:79]
  s_waitcnt lgkmcnt(0)
  v_mfma_f32_32x32x16_bf16 v[64:79], v[84:87], v[188:191], v[64:79]
  s_add_u32 s71, s71, 0x4000
  s_nop 4
  s_mov_b32 s50, s71
  buffer_load_dwordx4 v[128:131], v2, s[20:23], s50 offen offset:0 sc1
  buffer_load_dwordx4 v[132:135], v2, s[20:23], s50 offen offset:1024 sc1
  buffer_load_dwordx4 v[136:139], v2, s[20:23], s50 offen offset:2048 sc1
  buffer_load_dwordx4 v[140:143], v2, s[20:23], s50 offen offset:3072 sc1
  s_add_u32 s50, s50, 4096
  buffer_load_dwordx4 v[144:147], v2, s[20:23], s50 offen offset:0 sc1
  buffer_load_dwordx4 v[148:151], v2, s[20:23], s50 offen offset:1024 sc1
  buffer_load_dwordx4 v[152:155], v2, s[20:23], s50 offen offset:2048 sc1
  buffer_load_dwordx4 v[156:159], v2, s[20:23], s50 offen offset:3072 sc1
  s_add_u32 s50, s50, 4096
  buffer_load_dwordx4 v[160:163], v2, s[20:23], s50 offen offset:0 sc1
  buffer_load_dwordx4 v[164:167], v2, s[20:23], s50 offen offset:1024 sc1
  buffer_load_dwordx4 v[168:171], v2, s[20:23], s50 offen offset:2048 sc1
  buffer_load_dwordx4 v[172:175], v2, s[20:23], s50 offen offset:3072 sc1
  s_add_u32 s50, s50, 4096
  buffer_load_dwordx4 v[176:179], v2, s[20:23], s50 offen offset:0 sc1
  buffer_load_dwordx4 v[180:183], v2, s[20:23], s50 offen offset:1024 sc1
  buffer_load_dwordx4 v[184:187], v2, s[20:23], s50 offen offset:2048 sc1
  buffer_load_dwordx4 v[188:191], v2, s[20:23], s50 offen offset:3072 sc1
  s_mov_b32 s57, 0x4000
OVB1_LOOP:
  s_waitcnt vmcnt(0)
  v_max3_u32 v4, v128, v129, v130
  v_max3_u32 v4, v4, v131, v132
  v_max3_u32 v4, v4, v133, v134
  v_max3_u32 v4, v4, v135, v136
  v_max3_u32 v4, v4, v137, v138
  v_max3_u32 v4, v4, v139, v140
  v_max3_u32 v4, v4, v141, v142
  v_max3_u32 v4, v4, v143, v144
  v_max3_u32 v4, v4, v145, v146
  v_max3_u32 v4, v4, v147, v148
  v_max3_u32 v4, v4, v149, v150
  v_max3_u32 v4, v4, v151, v152
  v_max3_u32 v4, v4, v153, v154
  v_max3_u32 v4, v4, v155, v156
  v_max3_u32 v4, v4, v157, v158
  v_max3_u32 v4, v4, v159, v160
  v_max3_u32 v4, v4, v161, v162
  v_max3_u32 v4, v4, v163, v164
  v_max3_u32 v4, v4, v165, v166
  v_max3_u32 v4, v4, v167, v168
  v_max3_u32 v4, v4, v169, v170
  v_max3_u32 v4, v4, v171, v172
  v_max3_u32 v4, v4, v173, v174
  v_max3_u32 v4, v4, v175, v176
  v_max3_u32 v4, v4, v177, v178
  v_max3_u32 v4, v4, v179, v180
  v_max3_u32 v4, v4, v181, v182
  v_max3_u32 v4, v4, v183, v184
  v_max3_u32 v4, v4, v185, v186
  v_max3_u32 v4, v4, v187, v188
  v_max3_u32 v4, v4, v189, v190
  v_max_u32 v4, v4, v191
  v_cmp_eq_u32 vcc, -1, v4
  s_nop 4
  s_cbranch_vccz OVB1_OK
  v_lshlrev_b32 v5, 10, v1
  s_add_u32 s50, s71, 1020
  s_mov_b64 exec, 0xffff
OVB1_CAN:
  buffer_load_dword v6, v5, s[20:23], s50 offen sc1
  s_waitcnt vmcnt(0)
  v_cmp_eq_u32 vcc, -1, v6
  s_sub_u32 s57, s57, 1
  s_nop 3
  s_cbranch_vccz OVB1_CANOK
  s_sleep 2
  s_cmp_gt_i32 s57, 0
  s_cbranch_scc1 OVB1_CAN
OVB1_CANOK:
  s_mov_b64 exec, -1
  s_mov_b32 s50, s71
  buffer_load_dwordx4 v[128:131], v2, s[20:23], s50 offen offset:0 sc1
  buffer_load_dwordx4 v[132:135], v2, s[20:23], s50 offen offset:1024 sc1
  buffer_load_dwordx4 v[136:139], v2, s[20:23], s50 offen offset:2048 sc1
  buffer_load_dwordx4 v[140:143], v2, s[20:23], s50 offen offset:3072 sc1
  s_add_u32 s50, s50, 4096
  buffer_load_dwordx4 v[144:147], v2, s[20:23], s50 offen offset:0 sc1
  buffer_load_dwordx4 v[148:151], v2, s[20:23], s50 offen offset:1024 sc1
  buffer_load_dwordx4 v[152:155], v2, s[20:23], s50 offen offset:2048 sc1
  buffer_load_dwordx4 v[156:159], v2, s[20:23], s50 offen offset:3072 sc1
  s_add_u32 s50, s50, 4096
  buffer_load_dwordx4 v[160:163], v2, s[20:23], s50 offen offset:0 sc1
  buffer_load_dwordx4 v[164:167], v2, s[20:23], s50 offen offset:1024 sc1
  buffer_load_dwordx4 v[168:171], v2, s[20:23], s50 offen offset:2048 sc1
  buffer_load_dwordx4 v[172:175], v2, s[20:23], s50 offen offset:3072 sc1
  s_add_u32 s50, s50, 4096
  buffer_load_dwordx4 v[176:179], v2, s[20:23], s50 offen offset:0 sc1
  buffer_load_dwordx4 v[180:183], v2, s[20:23], s50 offen offset:1024 sc1
  buffer_load_dwordx4 v[184:187], v2, s[20:23], s50 offen offset:2048 sc1
  buffer_load_dwordx4 v[188:191], v2, s[20:23], s50 offen offset:3072 sc1
  s_sub_u32 s57, s57, 1
  s_cmp_gt_i32 s57, 0
  s_cbranch_scc1 OVB1_LOOP
  s_waitcnt vmcnt(0)
OVB1_OK:
  v_add_u32 v11, 0x18000, v10
  ds_read_b64_tr_b16 v[80:81], v11 offset:0
  ds_read_b64_tr_b16 v[82:83], v11 offset:512
  ds_read_b64_tr_b16 v[84:85], v11 offset:2048
  ds_read_b64_tr_b16 v[86:87], v11 offset:2560
  s_waitcnt lgkmcnt(2)
  v_mfma_f32_32x32x16_bf16 v[64:79], v[80:83], v[128:131], v[64:79]
  ds_read_b64_tr_b16 v[80:81], v11 offset:4096
  ds_read_b64_tr_b16 v[82:83], v11 offset:4608
  s_waitcnt lgkmcnt(2)
  v_mfma_f32_32x32x16_bf16 v[64:79], v[84:87], v[132:135], v[64:79]
  ds_read_b64_tr_b16 v[84:85], v11 offset:6144
  ds_read_b64_tr_b16 v[86:87], v11 offset:6656
  s_waitcnt lgkmcnt(2)
  v_mfma_f32_32x32x16_bf16 v[64:79], v[80:83], v[136:139], v[64:79]
  ds_read_b64_tr_b16 v[80:81], v11 offset:8192
  ds_read_b64_tr_b16 v[82:83], v11 offset:8704
  s_waitcnt lgkmcnt(2)
  v_mfma_f32_32x32x16_bf16 v[64:79], v[84:87], v[140:143], v[64:79]
  ds_read_b64_tr_b16 v[84:85], v11 offset:10240
  ds_read_b64_tr_b16 v[86:87], v11 offset:10752
  s_waitcnt lgkmcnt(2)
  v_mfma_f32_32x32x16_bf16 v[64:79], v[80:83], v[144:147], v[64:79]
  ds_read_b64_tr_b16 v[80:81], v11 offset:12288
  ds_read_b64_tr_b16 v[82:83], v11 offset:12800
  s_waitcnt lgkmcnt(2)
  v_mfma_f32_32x32x16_bf16 v[64:79], v[84:87], v[148:151], v[64:79]
  ds_read_b64_tr_b16 v[84:85], v11 offset:14336
  ds_read_b64_tr_b16 v[86:87], v11 offset:14848
  s_waitcnt lgkmcnt(2)
  v_mfma_f32_32x32x16_bf16 v[64:79], v[80:83], v[152:155], v[64:79]
  ds_read_b64_tr_b16 v[80:81], v11 offset:16384
  ds_read_b64_tr_b16 v[82:83], v11 offset:16896
  s_waitcnt lgkmcnt(2)
  v_mfma_f32_32x32x16_bf16 v[64:79], v[84:87], v[156:159], v[64:79]
  ds_read_b64_tr_b16 v[84:85], v11 offset:18432
  ds_read_b64_tr_b16 v[86:87], v11 offset:18944
  s_waitcnt lgkmcnt(2)
  v_mfma_f32_32x32x16_bf16 v[64:79], v[80:83], v[160:163], v[64:79]
  ds_read_b64_tr_b16 v[80:81], v11 offset:20480
  ds_read_b64_tr_b16 v[82:83], v11 offset:20992
  s_waitcnt lgkmcnt(2)
  v_mfma_f32_32x32x16_bf16 v[64:79], v[84:87], v[164:167], v[64:79]
  ds_read_b64_tr_b16 v[84:85], v11 offset:22528
  ds_read_b64_tr_b16 v[86:87], v11 offset:23040
  s_waitcnt lgkmcnt(2)
  v_mfma_f32_32x32x16_bf16 v[64:79], v[80:83], v[168:171], v[64:79]
  ds_read_b64_tr_b16 v[80:81], v11 offset:24576
  ds_read_b64_tr_b16 v[82:83], v11 offset:25088
  s_waitcnt lgkmcnt(2)
  v_mfma_f32_32x32x16_bf16 v[64:79], v[84:87], v[172:175], v[64:79]
  ds_read_b64_tr_b16 v[84:85], v11 offset:26624
  ds_read_b64_tr_b16 v[86:87], v11 offset:27136
  s_waitcnt lgkmcnt(2)
  v_mfma_f32_32x32x16_bf16 v[64:79], v[80:83], v[176:179], v[64:79]
  ds_read_b64_tr_b16 v[80:81], v11 offset:28672
  ds_read_b64_tr_b16 v[82:83], v11 offset:29184
  s_waitcnt lgkmcnt(2)
  v_mfma_f32_32x32x16_bf16 v[64:79], v[84:87], v[180:183], v[64:79]
  ds_read_b64_tr_b16 v[84:85], v11 offset:30720
  ds_read_b64_tr_b16 v[86:87], v11 offset:31232
  s_waitcnt lgkmcnt(2)
  v_mfma_f32_32x32x16_bf16 v[64:79], v[80:83], v[184:187], v[64:79]
  s_waitcnt lgkmcnt(0)
  v_mfma_f32_32x32x16_bf16 v[64:79], v[84:87], v[188:191], v[64:79]
  v_and_b32 v12, 31, v1
  v_lshlrev_b32 v12, 11, v12
  v_lshrrev_b32 v13, 5, v1
  v_lshlrev_b32 v13, 5, v13
  v_add_u32 v12, v12, v13
  s_lshl_b32 s50, s69, 16
  s_lshl_b32 s51, s65, 7
  s_add_u32 s50, s50, s51
  s_lshl_b32 s51, s67, 6
  s_add_u32 s50, s50, s51
  s_add_u32 s50, s50, 1024
  s_nop 7
  v_cvt_pk_bf16_f32 v80, v64, v65
  v_cvt_pk_bf16_f32 v81, v66, v67
  v_cvt_pk_bf16_f32 v82, v68, v69
  v_cvt_pk_bf16_f32 v83, v70, v71
  v_cvt_pk_bf16_f32 v84, v72, v73
  v_cvt_pk_bf16_f32 v85, v74, v75
  v_cvt_pk_bf16_f32 v86, v76, v77
  v_cvt_pk_bf16_f32 v87, v78, v79
  buffer_store_dwordx4 v[80:83], v12, s[88:91], s50 offen nt
  buffer_store_dwordx4 v[84:87], v12, s[88:91], s50 offen offset:16 nt
P3A:
  s_and_b32 s66, s3, 1
  s_lshr_b32 s68, s3, 1
  s_lshl_b32 s69, s64, 1
  s_add_u32 s69, s69, s66
  s_lshl_b32 s71, s69, 15
  s_lshl_b32 s72, s68, 13
  s_add_u32 s71, s71, s72
  s_add_u32 s71, s71, 0xc00000
  v_and_b32 v4, 1, v1
  v_lshlrev_b32 v4, 2, v4
  v_bfe_u32 v5, v1, 1, 1
  v_or_b32 v4, v4, v5
  v_bfe_u32 v5, v1, 4, 1
  v_lshlrev_b32 v5, 1, v5
  v_or_b32 v4, v4, v5
  v_lshlrev_b32 v4, 3, v4
  v_bfe_u32 v5, v1, 3, 1
  v_lshlrev_b32 v5, 6, v5
  v_xor_b32 v4, v4, v5
  v_bfe_u32 v5, v1, 2, 2
  v_lshlrev_b32 v5, 7, v5
  v_add_u32 v4, v4, v5
  v_lshrrev_b32 v5, 5, v1
  v_lshlrev_b32 v5, 10, v5
  v_add_u32 v10, v4, v5
  v_and_b32 v14, 31, v1
  v_lshlrev_b32 v15, 8, v14
  s_lshl_b32 s50, s68, 14
  s_lshl_b32 s51, s66, 13
  s_add_u32 s50, s50, s51
  v_add_u32 v15, s50, v15
  v_lshrrev_b32 v16, 5, v1
  v_lshlrev_b32 v16, 2, v16
  v_and_b32 v14, 15, v14
  v_xor_b32 v16, v16, v14
  v_lshrrev_b32 v17, 3, v1
  s_lshl_b32 s50, s3, 3
  v_add_u32 v17, s50, v17
  v_and_b32 v18, 15, v17
  v_and_b32 v19, 7, v1
  v_lshlrev_b32 v19, 1, v19
  v_xor_b32 v18, v18, v19
  v_lshlrev_b32 v19, 8, v17
  v_lshlrev_b32 v20, 4, v18
  v_add_u32 v20, v19, v20
  v_xor_b32 v21, 16, v20
  v_lshlrev_b32 v12, 11, v17
  v_and_b32 v13, 7, v1
  v_lshlrev_b32 v13, 4, v13
  v_add_u32 v12, v12, v13
  s_lshl_b32 s18, s64, 17
  s_lshl_b32 s51, s65, 7
  s_add_u32 s18, s18, s51
  s_mov_b32 s50, s71
  buffer_load_dwordx4 v[128:131], v2, s[20:23], s50 offen offset:0 sc1
  buffer_load_dwordx4 v[132:135], v2, s[20:23], s50 offen offset:1024 sc1
  buffer_load_dwordx4 v[136:139], v2, s[20:23], s50 offen offset:2048 sc1
  buffer_load_dwordx4 v[140:143], v2, s[20:23], s50 offen offset:3072 sc1
  s_add_u32 s50, s50, 4096
  buffer_load_dwordx4 v[144:147], v2, s[20:23], s50 offen offset:0 sc1
  buffer_load_dwordx4 v[148:151], v2, s[20:23], s50 offen offset:1024 sc1
  buffer_load_dwordx4 v[152:155], v2, s[20:23], s50 offen offset:2048 sc1
  buffer_load_dwordx4 v[156:159], v2, s[20:23], s50 offen offset:3072 sc1
  s_lshl_b32 s51, s68, 14
  v_add_u32 v11, s51, v10
  v_xor_b32 v13, 64, v11
  ds_read_b64_tr_b16 v[160:161], v11 offset:0
  ds_read_b64_tr_b16 v[162:163], v11 offset:512
  ds_read_b64_tr_b16 v[164:165], v13 offset:0
  ds_read_b64_tr_b16 v[166:167], v13 offset:512
  ds_read_b64_tr_b16 v[168:169], v11 offset:2048
  ds_read_b64_tr_b16 v[170:171], v11 offset:2560
  ds_read_b64_tr_b16 v[172:173], v13 offset:2048
  ds_read_b64_tr_b16 v[174:175], v13 offset:2560
  ds_read_b64_tr_b16 v[176:177], v11 offset:4096
  ds_read_b64_tr_b16 v[178:179], v11 offset:4608
  ds_read_b64_tr_b16 v[180:181], v13 offset:4096
  ds_read_b64_tr_b16 v[182:183], v13 offset:4608
  s_waitcnt lgkmcnt(4)
  ds_read_b64_tr_b16 v[184:185], v11 offset:6144
  ds_read_b64_tr_b16 v[186:187], v11 offset:6656
  ds_read_b64_tr_b16 v[188:189], v13 offset:6144
  ds_read_b64_tr_b16 v[190:191], v13 offset:6656
  ds_read_b64_tr_b16 v[28:29], v11 offset:8192
  ds_read_b64_tr_b16 v[30:31], v11 offset:8704
  ds_read_b64_tr_b16 v[32:33], v13 offset:8192
  ds_read_b64_tr_b16 v[34:35], v13 offset:8704
  s_waitcnt lgkmcnt(4)
  ds_read_b64_tr_b16 v[36:37], v11 offset:10240
  ds_read_b64_tr_b16 v[38:39], v11 offset:10752
  ds_read_b64_tr_b16 v[40:41], v13 offset:10240
  ds_read_b64_tr_b16 v[42:43], v13 offset:10752
  ds_read_b64_tr_b16 v[44:45], v11 offset:12288
  ds_read_b64_tr_b16 v[46:47], v11 offset:12800
  ds_read_b64_tr_b16 v[48:49], v13 offset:12288
  ds_read_b64_tr_b16 v[50:51], v13 offset:12800
  s_waitcnt lgkmcnt(4)
  ds_read_b64_tr_b16 v[52:53], v11 offset:14336
  ds_read_b64_tr_b16 v[54:55], v11 offset:14848
  ds_read_b64_tr_b16 v[56:57], v13 offset:14336
  ds_read_b64_tr_b16 v[58:59], v13 offset:14848
  s_mov_b32 s57, 0x4000
OVA_LOOP:
  s_waitcnt vmcnt(0)
  v_max3_u32 v4, v128, v129, v130
  v_max3_u32 v4, v4, v131, v132
  v_max3_u32 v4, v4, v133, v134
  v_max3_u32 v4, v4, v135, v136
  v_max3_u32 v4, v4, v137, v138
  v_max3_u32 v4, v4, v139, v140
  v_max3_u32 v4, v4, v141, v142
  v_max3_u32 v4, v4, v143, v144
  v_max3_u32 v4, v4, v145, v146
  v_max3_u32 v4, v4, v147, v148
  v_max3_u32 v4, v4, v149, v150
  v_max3_u32 v4, v4, v151, v152
  v_max3_u32 v4, v4, v153, v154
  v_max3_u32 v4, v4, v155, v156
  v_max3_u32 v4, v4, v157, v158
  v_max_u32 v4, v4, v159
  v_cmp_eq_u32 vcc, -1, v4
  s_nop 4
  s_cbranch_vccz OVA_OK
  v_lshlrev_b32 v5, 10, v1
  s_add_u32 s50, s71, 1020
  s_mov_b64 exec, 0xff
OVA_CAN:
  buffer_load_dword v6, v5, s[20:23], s50 offen sc1
  s_waitcnt vmcnt(0)
  v_cmp_eq_u32 vcc, -1, v6
  s_sub_u32 s57, s57, 1
  s_nop 3
  s_cbranch_vccz OVA_CANOK
  s_sleep 2
  s_cmp_gt_i32 s57, 0
  s_cbranch_scc1 OVA_CAN
OVA_CANOK:
  s_mov_b64 exec, -1
  s_mov_b32 s50, s71
  buffer_load_dwordx4 v[128:131], v2, s[20:23], s50 offen offset:0 sc1
  buffer_load_dwordx4 v[132:135], v2, s[20:23], s50 offen offset:1024 sc1
  buffer_load_dwordx4 v[136:139], v2, s[20:23], s50 offen offset:2048 sc1
  buffer_load_dwordx4 v[140:143], v2, s[20:23], s50 offen offset:3072 sc1
  s_add_u32 s50, s50, 4096
  buffer_load_dwordx4 v[144:147], v2, s[20:23], s50 offen offset:0 sc1
  buffer_load_dwordx4 v[148:151], v2, s[20:23], s50 offen offset:1024 sc1
  buffer_load_dwordx4 v[152:155], v2, s[20:23], s50 offen offset:2048 sc1
  buffer_load_dwordx4 v[156:159], v2, s[20:23], s50 offen offset:3072 sc1
  s_sub_u32 s57, s57, 1
  s_cmp_gt_i32 s57, 0
  s_cbranch_scc1 OVA_LOOP
  s_waitcnt vmcnt(0)
OVA_OK:
  s_waitcnt lgkmcnt(0)
  v_mfma_f32_32x32x16_bf16 v[64:79], v[160:163], v[128:131], 0
  v_mfma_f32_32x32x16_bf16 v[80:95], v[164:167], v[128:131], 0
  v_mfma_f32_32x32x16_bf16 v[64:79], v[168:171], v[132:135], v[64:79]
  v_mfma_f32_32x32x16_bf16 v[80:95], v[172:175], v[132:135], v[80:95]
  v_mfma_f32_32x32x16_bf16 v[64:79], v[176:179], v[136:139], v[64:79]
  v_mfma_f32_32x32x16_bf16 v[80:95], v[180:183], v[136:139], v[80:95]
  v_mfma_f32_32x32x16_bf16 v[64:79], v[184:187], v[140:143], v[64:79]
  v_mfma_f32_32x32x16_bf16 v[80:95], v[188:191], v[140:143], v[80:95]
  v_mfma_f32_32x32x16_bf16 v[64:79], v[28:31], v[144:147], v[64:79]
  v_mfma_f32_32x32x16_bf16 v[80:95], v[32:35], v[144:147], v[80:95]
  v_mfma_f32_32x32x16_bf16 v[64:79], v[36:39], v[148:151], v[64:79]
  v_mfma_f32_32x32x16_bf16 v[80:95], v[40:43], v[148:151], v[80:95]
  v_mfma_f32_32x32x16_bf16 v[64:79], v[44:47], v[152:155], v[64:79]
  v_mfma_f32_32x32x16_bf16 v[80:95], v[48:51], v[152:155], v[80:95]
  v_mfma_f32_32x32x16_bf16 v[64:79], v[52:55], v[156:159], v[64:79]
  v_mfma_f32_32x32x16_bf16 v[80:95], v[56:59], v[156:159], v[80:95]
  s_nop 7
  s_barrier
  v_xor_b32 v22, 0, v16
  v_lshlrev_b32 v22, 4, v22
  v_add_u32 v22, v15, v22
  ds_write_b128 v22, v[64:67]
  v_xor_b32 v22, 1, v16
  v_lshlrev_b32 v22, 4, v22
  v_add_u32 v22, v15, v22
  ds_write_b128 v22, v[68:71]
  v_xor_b32 v22, 2, v16
  v_lshlrev_b32 v22, 4, v22
  v_add_u32 v22, v15, v22
  ds_write_b128 v22, v[72:75]
  v_xor_b32 v22, 3, v16
  v_lshlrev_b32 v22, 4, v22
  v_add_u32 v22, v15, v22
  ds_write_b128 v22, v[76:79]
  v_xor_b32 v22, 8, v16
  v_lshlrev_b32 v22, 4, v22
  v_add_u32 v22, v15, v22
  ds_write_b128 v22, v[80:83]
  v_xor_b32 v22, 9, v16
  v_lshlrev_b32 v22, 4, v22
  v_add_u32 v22, v15, v22
  ds_write_b128 v22, v[84:87]
  v_xor_b32 v22, 10, v16
  v_lshlrev_b32 v22, 4, v22
  v_add_u32 v22, v15, v22
  ds_write_b128 v22, v[88:91]
  v_xor_b32 v22, 11, v16
  v_lshlrev_b32 v22, 4, v22
  v_add_u32 v22, v15, v22
  ds_write_b128 v22, v[92:95]
  s_waitcnt lgkmcnt(0)
  s_barrier
  ds_read_b128 v[96:99], v20 offset:0
  ds_read_b128 v[100:103], v21 offset:0
  ds_read_b128 v[104:107], v20 offset:16384
  ds_read_b128 v[108:111], v21 offset:16384
  ds_read_b128 v[112:115], v20 offset:32768
  ds_read_b128 v[116:119], v21 offset:32768
  ds_read_b128 v[120:123], v20 offset:49152
  ds_read_b128 v[124:127], v21 offset:49152
  s_waitcnt lgkmcnt(4)
  v_add_f32 v96, v96, v104
  v_add_f32 v97, v97, v105
  v_add_f32 v98, v98, v106
  v_add_f32 v99, v99, v107
  v_add_f32 v100, v100, v108
  v_add_f32 v101, v101, v109
  v_add_f32 v102, v102, v110
  v_add_f32 v103, v103, v111
  s_waitcnt lgkmcnt(0)
  v_add_f32 v112, v112, v120
  v_add_f32 v113, v113, v121
  v_add_f32 v114, v114, v122
  v_add_f32 v115, v115, v123
  v_add_f32 v116, v116, v124
  v_add_f32 v117, v117, v125
  v_add_f32 v118, v118, v126
  v_add_f32 v119, v119, v127
  v_add_f32 v96, v96, v112
  v_add_f32 v97, v97, v113
  v_add_f32 v98, v98, v114
  v_add_f32 v99, v99, v115
  v_add_f32 v100, v100, v116
  v_add_f32 v101, v101, v117
  v_add_f32 v102, v102, v118
  v_add_f32 v103, v103, v119
  v_cvt_pk_bf16_f32 v104, v96, v97
  v_cvt_pk_bf16_f32 v105, v98, v99
  v_cvt_pk_bf16_f32 v106, v100, v101
  v_cvt_pk_bf16_f32 v107, v102, v103
  buffer_store_dwordx4 v[104:107], v12, s[88:91], s18 offen nt
  s_or_b32 s50, s2, s3
  s_cmp_lg_u32 s50, 0
  s_cbranch_scc1 K_FIN
  v_mov_b32 v4, 0
  v_mov_b32 v5, 0
  v_mov_b32 v6, 0
  s_mov_b64 exec, 1
  global_store_dwordx2 v6, v[4:5], s[46:47] sc1
  s_mov_b64 exec, -1
K_FIN:
K_END:
  s_endpgm
K_HOT_END:
A_FALLBACK:
  v_mov_b32 v4, 0xff800000
  v_mov_b32 v160, 0xff800000
  s_mov_b32 s24, 0
AF_MAX:
  s_lshl_b32 s26, s24, 11
  s_add_u32 s26, s26, s9
  buffer_load_dwordx4 v[20:23], v2, s[20:23], s26 offen sc1
  s_waitcnt vmcnt(0)
  v_mfma_f32_32x32x16_bf16 v[64:79], v[20:23], v[8:11], 0
  v_mfma_f32_32x32x16_bf16 v[80:95], v[20:23], v[12:15], 0
  s_nop 15
  v_max3_f32 v4, v4, v64, v65
  v_max3_f32 v4, v4, v66, v67
  v_max3_f32 v4, v4, v68, v69
  v_max3_f32 v4, v4, v70, v71
  v_max3_f32 v4, v4, v72, v73
  v_max3_f32 v4, v4, v74, v75
  v_max3_f32 v4, v4, v76, v77
  v_max3_f32 v4, v4, v78, v79
  v_max3_f32 v160, v160, v80, v81
  v_max3_f32 v160, v160, v82, v83
  v_max3_f32 v160, v160, v84, v85
  v_max3_f32 v160, v160, v86, v87
  v_max3_f32 v160, v160, v88, v89
  v_max3_f32 v160, v160, v90, v91
  v_max3_f32 v160, v160, v92, v93
  v_max3_f32 v160, v160, v94, v95
  s_add_u32 s24, s24, 1
  s_cmp_lg_u32 s24, 64
  s_cbranch_scc1 AF_MAX
  v_mov_b32 v5, v4
  s_nop 1
  v_permlane32_swap_b32 v4, v5
  s_nop 1
  v_max_f32 v4, v4, v5
  v_mov_b32 v161, v160
  s_nop 1
  v_permlane32_swap_b32 v160, v161
  s_nop 1
  v_max_f32 v160, v160, v161
  v_sub_f32 v128, 0, v4
  v_sub_f32 v144, 0, v160
  v_mov_b32 v192, 0
  v_mov_b32 v208, 0
  v_sub_f32 v129, 0, v4
  v_sub_f32 v145, 0, v160
  v_mov_b32 v193, 0
  v_mov_b32 v209, 0
  v_sub_f32 v130, 0, v4
  v_sub_f32 v146, 0, v160
  v_mov_b32 v194, 0
  v_mov_b32 v210, 0
  v_sub_f32 v131, 0, v4
  v_sub_f32 v147, 0, v160
  v_mov_b32 v195, 0
  v_mov_b32 v211, 0
  v_sub_f32 v132, 0, v4
  v_sub_f32 v148, 0, v160
  v_mov_b32 v196, 0
  v_mov_b32 v212, 0
  v_sub_f32 v133, 0, v4
  v_sub_f32 v149, 0, v160
  v_mov_b32 v197, 0
  v_mov_b32 v213, 0
  v_sub_f32 v134, 0, v4
  v_sub_f32 v150, 0, v160
  v_mov_b32 v198, 0
  v_mov_b32 v214, 0
  v_sub_f32 v135, 0, v4
  v_sub_f32 v151, 0, v160
  v_mov_b32 v199, 0
  v_mov_b32 v215, 0
  v_sub_f32 v136, 0, v4
  v_sub_f32 v152, 0, v160
  v_mov_b32 v200, 0
  v_mov_b32 v216, 0
  v_sub_f32 v137, 0, v4
  v_sub_f32 v153, 0, v160
  v_mov_b32 v201, 0
  v_mov_b32 v217, 0
  v_sub_f32 v138, 0, v4
  v_sub_f32 v154, 0, v160
  v_mov_b32 v202, 0
  v_mov_b32 v218, 0
  v_sub_f32 v139, 0, v4
  v_sub_f32 v155, 0, v160
  v_mov_b32 v203, 0
  v_mov_b32 v219, 0
  v_sub_f32 v140, 0, v4
  v_sub_f32 v156, 0, v160
  v_mov_b32 v204, 0
  v_mov_b32 v220, 0
  v_sub_f32 v141, 0, v4
  v_sub_f32 v157, 0, v160
  v_mov_b32 v205, 0
  v_mov_b32 v221, 0
  v_sub_f32 v142, 0, v4
  v_sub_f32 v158, 0, v160
  v_mov_b32 v206, 0
  v_mov_b32 v222, 0
  v_sub_f32 v143, 0, v4
  v_sub_f32 v159, 0, v160
  v_mov_b32 v207, 0
  v_mov_b32 v223, 0
  s_mov_b32 s24, 0
AF_LOOP:
  s_lshl_b32 s26, s24, 11
  s_add_u32 s26, s26, s9
  buffer_load_dwordx4 v[20:23], v2, s[20:23], s26 offen sc1
  s_mov_b64 exec, s[16:17]
  buffer_load_dwordx4 v[176:179], v3, s[20:23], s26 offen sc1
  buffer_load_dwordx4 v[180:183], v3, s[20:23], s26 offen offset:512 sc1
  s_mov_b64 exec, -1
  s_waitcnt vmcnt(0)
  v_mfma_f32_32x32x16_bf16 v[64:79], v[20:23], v[8:11], v[128:143]
  s_nop 15
  v_exp_f32 v64, v64
  v_exp_f32 v65, v65
  v_exp_f32 v66, v66
  v_exp_f32 v67, v67
  v_exp_f32 v68, v68
  v_exp_f32 v69, v69
  v_exp_f32 v70, v70
  v_exp_f32 v71, v71
  v_exp_f32 v72, v72
  v_exp_f32 v73, v73
  v_exp_f32 v74, v74
  v_exp_f32 v75, v75
  v_exp_f32 v76, v76
  v_exp_f32 v77, v77
  v_exp_f32 v78, v78
  v_exp_f32 v79, v79
  s_nop 0
  v_cvt_pk_bf16_f32 v224, v64, v65
  v_cvt_pk_bf16_f32 v225, v66, v67
  v_cvt_pk_bf16_f32 v226, v68, v69
  v_cvt_pk_bf16_f32 v227, v70, v71
  v_cvt_pk_bf16_f32 v228, v72, v73
  v_cvt_pk_bf16_f32 v229, v74, v75
  v_cvt_pk_bf16_f32 v230, v76, v77
  v_cvt_pk_bf16_f32 v231, v78, v79
  s_nop 1
  v_mfma_f32_32x32x16_bf16 v[192:207], v[176:179], v[224:227], v[192:207]
  v_mfma_f32_32x32x16_bf16 v[192:207], v[180:183], v[228:231], v[192:207]
  v_mfma_f32_32x32x16_bf16 v[64:79], v[20:23], v[12:15], v[144:159]
  s_nop 15
  v_exp_f32 v64, v64
  v_exp_f32 v65, v65
  v_exp_f32 v66, v66
  v_exp_f32 v67, v67
  v_exp_f32 v68, v68
  v_exp_f32 v69, v69
  v_exp_f32 v70, v70
  v_exp_f32 v71, v71
  v_exp_f32 v72, v72
  v_exp_f32 v73, v73
  v_exp_f32 v74, v74
  v_exp_f32 v75, v75
  v_exp_f32 v76, v76
  v_exp_f32 v77, v77
  v_exp_f32 v78, v78
  v_exp_f32 v79, v79
  s_nop 0
  v_cvt_pk_bf16_f32 v224, v64, v65
  v_cvt_pk_bf16_f32 v225, v66, v67
  v_cvt_pk_bf16_f32 v226, v68, v69
  v_cvt_pk_bf16_f32 v227, v70, v71
  v_cvt_pk_bf16_f32 v228, v72, v73
  v_cvt_pk_bf16_f32 v229, v74, v75
  v_cvt_pk_bf16_f32 v230, v76, v77
  v_cvt_pk_bf16_f32 v231, v78, v79
  s_nop 1
  v_mfma_f32_32x32x16_bf16 v[208:223], v[176:179], v[224:227], v[208:223]
  v_mfma_f32_32x32x16_bf16 v[208:223], v[180:183], v[228:231], v[208:223]
  s_add_u32 s24, s24, 1
  s_cmp_lg_u32 s24, 64
  s_cbranch_scc1 AF_LOOP
  s_nop 15
  s_nop 3
  s_branch A_FIN
B_EXIT1:
  v_mfma_f32_32x32x16_bf16 v[28:43], v[188:191], v[236:239], v[28:43]
  s_branch B_TAIL
B_SLOW:
  v_mov_b32 v5, 0xff800000
  v_xor_b32 v224, v112, v5
  v_mov_b32 v192, v5
  v_xor_b32 v225, v113, v5
  v_mov_b32 v193, v5
  v_xor_b32 v226, v114, v5
  v_mov_b32 v194, v5
  v_xor_b32 v227, v115, v5
  v_mov_b32 v195, v5
  v_xor_b32 v228, v116, v5
  v_mov_b32 v196, v5
  v_xor_b32 v229, v117, v5
  v_mov_b32 v197, v5
  v_xor_b32 v230, v118, v5
  v_mov_b32 v198, v5
  v_xor_b32 v231, v119, v5
  v_mov_b32 v199, v5
  v_xor_b32 v232, v120, v5
  v_mov_b32 v200, v5
  v_xor_b32 v233, v121, v5
  v_mov_b32 v201, v5
  v_xor_b32 v234, v122, v5
  v_mov_b32 v202, v5
  v_xor_b32 v235, v123, v5
  v_mov_b32 v203, v5
  v_xor_b32 v236, v124, v5
  v_mov_b32 v204, v5
  v_xor_b32 v237, v125, v5
  v_mov_b32 v205, v5
  v_xor_b32 v238, v126, v5
  v_mov_b32 v206, v5
  v_xor_b32 v239, v127, v5
  v_mov_b32 v207, v5
  ds_read_b128 v[160:163], v6 offset:16384
  ds_read_b128 v[156:159], v6 offset:14336
  ds_read_b128 v[152:155], v6 offset:12288
  ds_read_b128 v[148:151], v6 offset:10240
  ds_read_b128 v[144:147], v6 offset:8192
  ds_read_b128 v[140:143], v6 offset:6144
  ds_read_b128 v[136:139], v6 offset:4096
  ds_read_b128 v[132:135], v6 offset:2048
  ds_read_b128 v[128:131], v6 offset:0
  s_waitcnt lgkmcnt(0)
  v_mfma_f32_32x32x16_bf16 v[64:79], v[160:163], v[60:63], v[112:127]
  s_nop 15
  v_max3_f32 v4, v64, v65, v66
  v_max3_f32 v4, v4, v67, v68
  v_max3_f32 v4, v4, v69, v70
  v_max3_f32 v4, v4, v71, v72
  v_max3_f32 v4, v4, v73, v74
  v_max3_f32 v4, v4, v75, v76
  v_max3_f32 v4, v4, v77, v78
  v_max_f32 v4, v4, v79
  s_cmp_lt_u32 s8, 1
  s_cbranch_scc1 LB1_7_inv
  v_mfma_f32_32x32x16_bf16 v[64:79], v[156:159], v[60:63], 0
  s_branch LB1_7_done
LB1_7_inv:
  v_mfma_f32_32x32x16_bf16 v[64:79], v[156:159], v[60:63], v[192:207]
LB1_7_done:
  s_nop 15
  v_max3_f32 v4, v4, v64, v65
  v_max3_f32 v4, v4, v66, v67
  v_max3_f32 v4, v4, v68, v69
  v_max3_f32 v4, v4, v70, v71
  v_max3_f32 v4, v4, v72, v73
  v_max3_f32 v4, v4, v74, v75
  v_max3_f32 v4, v4, v76, v77
  v_max3_f32 v4, v4, v78, v79
  s_cmp_lt_u32 s8, 2
  s_cbranch_scc1 LB1_6_inv
  v_mfma_f32_32x32x16_bf16 v[64:79], v[152:155], v[60:63], 0
  s_branch LB1_6_done
LB1_6_inv:
  v_mfma_f32_32x32x16_bf16 v[64:79], v[152:155], v[60:63], v[192:207]
LB1_6_done:
  s_nop 15
  v_max3_f32 v4, v4, v64, v65
  v_max3_f32 v4, v4, v66, v67
  v_max3_f32 v4, v4, v68, v69
  v_max3_f32 v4, v4, v70, v71
  v_max3_f32 v4, v4, v72, v73
  v_max3_f32 v4, v4, v74, v75
  v_max3_f32 v4, v4, v76, v77
  v_max3_f32 v4, v4, v78, v79
  s_cmp_lt_u32 s8, 3
  s_cbranch_scc1 LB1_5_inv
  v_mfma_f32_32x32x16_bf16 v[64:79], v[148:151], v[60:63], 0
  s_branch LB1_5_done
LB1_5_inv:
  v_mfma_f32_32x32x16_bf16 v[64:79], v[148:151], v[60:63], v[192:207]
LB1_5_done:
  s_nop 15
  v_max3_f32 v4, v4, v64, v65
  v_max3_f32 v4, v4, v66, v67
  v_max3_f32 v4, v4, v68, v69
  v_max3_f32 v4, v4, v70, v71
  v_max3_f32 v4, v4, v72, v73
  v_max3_f32 v4, v4, v74, v75
  v_max3_f32 v4, v4, v76, v77
  v_max3_f32 v4, v4, v78, v79
  s_cmp_lt_u32 s8, 4
  s_cbranch_scc1 LB1_4_inv
  v_mfma_f32_32x32x16_bf16 v[64:79], v[144:147], v[60:63], 0
  s_branch LB1_4_done
LB1_4_inv:
  v_mfma_f32_32x32x16_bf16 v[64:79], v[144:147], v[60:63], v[192:207]
LB1_4_done:
  s_nop 15
  v_max3_f32 v4, v4, v64, v65
  v_max3_f32 v4, v4, v66, v67
  v_max3_f32 v4, v4, v68, v69
  v_max3_f32 v4, v4, v70, v71
  v_max3_f32 v4, v4, v72, v73
  v_max3_f32 v4, v4, v74, v75
  v_max3_f32 v4, v4, v76, v77
  v_max3_f32 v4, v4, v78, v79
  s_cmp_lt_u32 s8, 5
  s_cbranch_scc1 LB1_3_inv
  v_mfma_f32_32x32x16_bf16 v[64:79], v[140:143], v[60:63], 0
  s_branch LB1_3_done
LB1_3_inv:
  v_mfma_f32_32x32x16_bf16 v[64:79], v[140:143], v[60:63], v[192:207]
LB1_3_done:
  s_nop 15
  v_max3_f32 v4, v4, v64, v65
  v_max3_f32 v4, v4, v66, v67
  v_max3_f32 v4, v4, v68, v69
  v_max3_f32 v4, v4, v70, v71
  v_max3_f32 v4, v4, v72, v73
  v_max3_f32 v4, v4, v74, v75
  v_max3_f32 v4, v4, v76, v77
  v_max3_f32 v4, v4, v78, v79
  s_cmp_lt_u32 s8, 6
  s_cbranch_scc1 LB1_2_inv
  v_mfma_f32_32x32x16_bf16 v[64:79], v[136:139], v[60:63], 0
  s_branch LB1_2_done
LB1_2_inv:
  v_mfma_f32_32x32x16_bf16 v[64:79], v[136:139], v[60:63], v[192:207]
LB1_2_done:
  s_nop 15
  v_max3_f32 v4, v4, v64, v65
  v_max3_f32 v4, v4, v66, v67
  v_max3_f32 v4, v4, v68, v69
  v_max3_f32 v4, v4, v70, v71
  v_max3_f32 v4, v4, v72, v73
  v_max3_f32 v4, v4, v74, v75
  v_max3_f32 v4, v4, v76, v77
  v_max3_f32 v4, v4, v78, v79
  s_cmp_lt_u32 s8, 7
  s_cbranch_scc1 LB1_1_inv
  v_mfma_f32_32x32x16_bf16 v[64:79], v[132:135], v[60:63], 0
  s_branch LB1_1_done
LB1_1_inv:
  v_mfma_f32_32x32x16_bf16 v[64:79], v[132:135], v[60:63], v[192:207]
LB1_1_done:
  s_nop 15
  v_max3_f32 v4, v4, v64, v65
  v_max3_f32 v4, v4, v66, v67
  v_max3_f32 v4, v4, v68, v69
  v_max3_f32 v4, v4, v70, v71
  v_max3_f32 v4, v4, v72, v73
  v_max3_f32 v4, v4, v74, v75
  v_max3_f32 v4, v4, v76, v77
  v_max3_f32 v4, v4, v78, v79
  s_cmp_lt_u32 s8, 8
  s_cbranch_scc1 LB1_0_inv
  v_mfma_f32_32x32x16_bf16 v[64:79], v[128:131], v[60:63], v[224:239]
  s_branch LB1_0_done
LB1_0_inv:
  v_mfma_f32_32x32x16_bf16 v[64:79], v[128:131], v[60:63], v[192:207]
LB1_0_done:
  s_nop 15
  v_max3_f32 v4, v4, v64, v65
  v_max3_f32 v4, v4, v66, v67
  v_max3_f32 v4, v4, v68, v69
  v_max3_f32 v4, v4, v70, v71
  v_max3_f32 v4, v4, v72, v73
  v_max3_f32 v4, v4, v74, v75
  v_max3_f32 v4, v4, v76, v77
  v_max3_f32 v4, v4, v78, v79
  v_mov_b32 v5, v4
  s_nop 1
  v_permlane32_swap_b32 v4, v5
  s_nop 1
  v_max_f32 v4, v4, v5
  v_sub_f32 v12, 0, v4
  v_sub_f32 v44, v112, v4
  v_sub_f32 v224, v224, v4
  v_mov_b32 v208, 0
  v_sub_f32 v13, 0, v4
  v_sub_f32 v45, v113, v4
  v_sub_f32 v225, v225, v4
  v_mov_b32 v209, 0
  v_sub_f32 v14, 0, v4
  v_sub_f32 v46, v114, v4
  v_sub_f32 v226, v226, v4
  v_mov_b32 v210, 0
  v_sub_f32 v15, 0, v4
  v_sub_f32 v47, v115, v4
  v_sub_f32 v227, v227, v4
  v_mov_b32 v211, 0
  v_sub_f32 v16, 0, v4
  v_sub_f32 v48, v116, v4
  v_sub_f32 v228, v228, v4
  v_mov_b32 v212, 0
  v_sub_f32 v17, 0, v4
  v_sub_f32 v49, v117, v4
  v_sub_f32 v229, v229, v4
  v_mov_b32 v213, 0
  v_sub_f32 v18, 0, v4
  v_sub_f32 v50, v118, v4
  v_sub_f32 v230, v230, v4
  v_mov_b32 v214, 0
  v_sub_f32 v19, 0, v4
  v_sub_f32 v51, v119, v4
  v_sub_f32 v231, v231, v4
  v_mov_b32 v215, 0
  v_sub_f32 v20, 0, v4
  v_sub_f32 v52, v120, v4
  v_sub_f32 v232, v232, v4
  v_mov_b32 v216, 0
  v_sub_f32 v21, 0, v4
  v_sub_f32 v53, v121, v4
  v_sub_f32 v233, v233, v4
  v_mov_b32 v217, 0
  v_sub_f32 v22, 0, v4
  v_sub_f32 v54, v122, v4
  v_sub_f32 v234, v234, v4
  v_mov_b32 v218, 0
  v_sub_f32 v23, 0, v4
  v_sub_f32 v55, v123, v4
  v_sub_f32 v235, v235, v4
  v_mov_b32 v219, 0
  v_sub_f32 v24, 0, v4
  v_sub_f32 v56, v124, v4
  v_sub_f32 v236, v236, v4
  v_mov_b32 v220, 0
  v_sub_f32 v25, 0, v4
  v_sub_f32 v57, v125, v4
  v_sub_f32 v237, v237, v4
  v_mov_b32 v221, 0
  v_sub_f32 v26, 0, v4
  v_sub_f32 v58, v126, v4
  v_sub_f32 v238, v238, v4
  v_mov_b32 v222, 0
  v_sub_f32 v27, 0, v4
  v_sub_f32 v59, v127, v4
  v_sub_f32 v239, v239, v4
  v_mov_b32 v223, 0
  v_mov_b32 v40, 0
  v_mov_b32 v41, 0
  v_mov_b32 v42, 0
  v_mov_b32 v43, 0
  s_mov_b64 exec, s[16:17]
  ds_read_b128 v[176:179], v7 offset:16384
  ds_read_b128 v[180:183], v7 offset:16896
  s_mov_b64 exec, -1
  v_mfma_f32_32x32x16_bf16 v[64:79], v[160:163], v[60:63], v[44:59]
  s_nop 15
  s_cmp_lt_u32 s8, 1
  s_cbranch_scc1 LB2_7_inv
  v_mfma_f32_32x32x16_bf16 v[80:95], v[156:159], v[60:63], v[12:27]
  s_branch LB2_7_done
LB2_7_inv:
  v_mfma_f32_32x32x16_bf16 v[80:95], v[156:159], v[60:63], v[192:207]
LB2_7_done:
  v_exp_f32 v64, v64
  v_exp_f32 v65, v65
  v_exp_f32 v66, v66
  v_exp_f32 v67, v67
  v_cvt_pk_bf16_f32 v28, v64, v65
  v_mfma_f32_32x32x16_bf16 v[208:223], v[188:191], v[40:43], v[208:223]
  s_mov_b64 exec, s[16:17]
  ds_read_b128 v[184:187], v7 offset:14336
  ds_read_b128 v[188:191], v7 offset:14848
  s_mov_b64 exec, -1
  v_exp_f32 v68, v68
  v_exp_f32 v69, v69
  v_cvt_pk_bf16_f32 v29, v66, v67
  v_exp_f32 v70, v70
  v_exp_f32 v71, v71
  v_cvt_pk_bf16_f32 v30, v68, v69
  v_exp_f32 v72, v72
  v_exp_f32 v73, v73
  v_cvt_pk_bf16_f32 v31, v70, v71
  v_exp_f32 v74, v74
  v_exp_f32 v75, v75
  v_cvt_pk_bf16_f32 v32, v72, v73
  s_waitcnt lgkmcnt(2)
  v_mfma_f32_32x32x16_bf16 v[208:223], v[176:179], v[28:31], v[208:223]
  v_exp_f32 v76, v76
  v_exp_f32 v77, v77
  v_cvt_pk_bf16_f32 v33, v74, v75
  v_exp_f32 v78, v78
  v_exp_f32 v79, v79
  v_cvt_pk_bf16_f32 v34, v76, v77
  v_cvt_pk_bf16_f32 v35, v78, v79
  s_cmp_lt_u32 s8, 2
  s_cbranch_scc1 LB2_6_inv
  v_mfma_f32_32x32x16_bf16 v[64:79], v[152:155], v[60:63], v[12:27]
  s_branch LB2_6_done
LB2_6_inv:
  v_mfma_f32_32x32x16_bf16 v[64:79], v[152:155], v[60:63], v[192:207]
LB2_6_done:
  v_exp_f32 v80, v80
  v_exp_f32 v81, v81
  v_exp_f32 v82, v82
  v_exp_f32 v83, v83
  v_cvt_pk_bf16_f32 v36, v80, v81
  v_mfma_f32_32x32x16_bf16 v[208:223], v[180:183], v[32:35], v[208:223]
  s_mov_b64 exec, s[16:17]
  ds_read_b128 v[176:179], v7 offset:12288
  ds_read_b128 v[180:183], v7 offset:12800
  s_mov_b64 exec, -1
  v_exp_f32 v84, v84
  v_exp_f32 v85, v85
  v_cvt_pk_bf16_f32 v37, v82, v83
  v_exp_f32 v86, v86
  v_exp_f32 v87, v87
  v_cvt_pk_bf16_f32 v38, v84, v85
  v_exp_f32 v88, v88
  v_exp_f32 v89, v89
  v_cvt_pk_bf16_f32 v39, v86, v87
  v_exp_f32 v90, v90
  v_exp_f32 v91, v91
  v_cvt_pk_bf16_f32 v40, v88, v89
  s_waitcnt lgkmcnt(2)
  v_mfma_f32_32x32x16_bf16 v[208:223], v[184:187], v[36:39], v[208:223]
  v_exp_f32 v92, v92
  v_exp_f32 v93, v93
  v_cvt_pk_bf16_f32 v41, v90, v91
  v_exp_f32 v94, v94
  v_exp_f32 v95, v95
  v_cvt_pk_bf16_f32 v42, v92, v93
  v_cvt_pk_bf16_f32 v43, v94, v95
  s_cmp_lt_u32 s8, 3
  s_cbranch_scc1 LB2_5_inv
  v_mfma_f32_32x32x16_bf16 v[80:95], v[148:151], v[60:63], v[12:27]
  s_branch LB2_5_done
LB2_5_inv:
  v_mfma_f32_32x32x16_bf16 v[80:95], v[148:151], v[60:63], v[192:207]
LB2_5_done:
  v_exp_f32 v64, v64
  v_exp_f32 v65, v65
  v_exp_f32 v66, v66
  v_exp_f32 v67, v67
  v_cvt_pk_bf16_f32 v28, v64, v65
  v_mfma_f32_32x32x16_bf16 v[208:223], v[188:191], v[40:43], v[208:223]
  s_mov_b64 exec, s[16:17]
  ds_read_b128 v[184:187], v7 offset:10240
  ds_read_b128 v[188:191], v7 offset:10752
  s_mov_b64 exec, -1
  v_exp_f32 v68, v68
  v_exp_f32 v69, v69
  v_cvt_pk_bf16_f32 v29, v66, v67
  v_exp_f32 v70, v70
  v_exp_f32 v71, v71
  v_cvt_pk_bf16_f32 v30, v68, v69
  v_exp_f32 v72, v72
  v_exp_f32 v73, v73
  v_cvt_pk_bf16_f32 v31, v70, v71
  v_exp_f32 v74, v74
  v_exp_f32 v75, v75
  v_cvt_pk_bf16_f32 v32, v72, v73
  s_waitcnt lgkmcnt(2)
  v_mfma_f32_32x32x16_bf16 v[208:223], v[176:179], v[28:31], v[208:223]
  v_exp_f32 v76, v76
  v_exp_f32 v77, v77
  v_cvt_pk_bf16_f32 v33, v74, v75
  v_exp_f32 v78, v78
  v_exp_f32 v79, v79
  v_cvt_pk_bf16_f32 v34, v76, v77
  v_cvt_pk_bf16_f32 v35, v78, v79
  s_cmp_lt_u32 s8, 4
  s_cbranch_scc1 LB2_4_inv
  v_mfma_f32_32x32x16_bf16 v[64:79], v[144:147], v[60:63], v[12:27]
  s_branch LB2_4_done
LB2_4_inv:
  v_mfma_f32_32x32x16_bf16 v[64:79], v[144:147], v[60:63], v[192:207]
LB2_4_done:
  v_exp_f32 v80, v80
  v_exp_f32 v81, v81
  v_exp_f32 v82, v82
  v_exp_f32 v83, v83
  v_cvt_pk_bf16_f32 v36, v80, v81
  v_mfma_f32_32x32x16_bf16 v[208:223], v[180:183], v[32:35], v[208:223]
  s_mov_b64 exec, s[16:17]
  ds_read_b128 v[176:179], v7 offset:8192
  ds_read_b128 v[180:183], v7 offset:8704
  s_mov_b64 exec, -1
  v_exp_f32 v84, v84
  v_exp_f32 v85, v85
  v_cvt_pk_bf16_f32 v37, v82, v83
  v_exp_f32 v86, v86
  v_exp_f32 v87, v87
  v_cvt_pk_bf16_f32 v38, v84, v85
  v_exp_f32 v88, v88
  v_exp_f32 v89, v89
  v_cvt_pk_bf16_f32 v39, v86, v87
  v_exp_f32 v90, v90
  v_exp_f32 v91, v91
  v_cvt_pk_bf16_f32 v40, v88, v89
  s_waitcnt lgkmcnt(2)
  v_mfma_f32_32x32x16_bf16 v[208:223], v[184:187], v[36:39], v[208:223]
  v_exp_f32 v92, v92
  v_exp_f32 v93, v93
  v_cvt_pk_bf16_f32 v41, v90, v91
  v_exp_f32 v94, v94
  v_exp_f32 v95, v95
  v_cvt_pk_bf16_f32 v42, v92, v93
  v_cvt_pk_bf16_f32 v43, v94, v95
  s_cmp_lt_u32 s8, 5
  s_cbranch_scc1 LB2_3_inv
  v_mfma_f32_32x32x16_bf16 v[80:95], v[140:143], v[60:63], v[12:27]
  s_branch LB2_3_done
LB2_3_inv:
  v_mfma_f32_32x32x16_bf16 v[80:95], v[140:143], v[60:63], v[192:207]
LB2_3_done:
  v_exp_f32 v64, v64
  v_exp_f32 v65, v65
  v_exp_f32 v66, v66
  v_exp_f32 v67, v67
  v_cvt_pk_bf16_f32 v28, v64, v65
  v_mfma_f32_32x32x16_bf16 v[208:223], v[188:191], v[40:43], v[208:223]
  s_mov_b64 exec, s[16:17]
  ds_read_b128 v[184:187], v7 offset:6144
  ds_read_b128 v[188:191], v7 offset:6656
  s_mov_b64 exec, -1
  v_exp_f32 v68, v68
  v_exp_f32 v69, v69
  v_cvt_pk_bf16_f32 v29, v66, v67
  v_exp_f32 v70, v70
  v_exp_f32 v71, v71
  v_cvt_pk_bf16_f32 v30, v68, v69
  v_exp_f32 v72, v72
  v_exp_f32 v73, v73
  v_cvt_pk_bf16_f32 v31, v70, v71
  v_exp_f32 v74, v74
  v_exp_f32 v75, v75
  v_cvt_pk_bf16_f32 v32, v72, v73
  s_waitcnt lgkmcnt(2)
  v_mfma_f32_32x32x16_bf16 v[208:223], v[176:179], v[28:31], v[208:223]
  v_exp_f32 v76, v76
  v_exp_f32 v77, v77
  v_cvt_pk_bf16_f32 v33, v74, v75
  v_exp_f32 v78, v78
  v_exp_f32 v79, v79
  v_cvt_pk_bf16_f32 v34, v76, v77
  v_cvt_pk_bf16_f32 v35, v78, v79
  s_cmp_lt_u32 s8, 6
  s_cbranch_scc1 LB2_2_inv
  v_mfma_f32_32x32x16_bf16 v[64:79], v[136:139], v[60:63], v[12:27]
  s_branch LB2_2_done
LB2_2_inv:
  v_mfma_f32_32x32x16_bf16 v[64:79], v[136:139], v[60:63], v[192:207]
LB2_2_done:
  v_exp_f32 v80, v80
  v_exp_f32 v81, v81
  v_exp_f32 v82, v82
  v_exp_f32 v83, v83
  v_cvt_pk_bf16_f32 v36, v80, v81
  v_mfma_f32_32x32x16_bf16 v[208:223], v[180:183], v[32:35], v[208:223]
  s_mov_b64 exec, s[16:17]
  ds_read_b128 v[176:179], v7 offset:4096
  ds_read_b128 v[180:183], v7 offset:4608
  s_mov_b64 exec, -1
  v_exp_f32 v84, v84
  v_exp_f32 v85, v85
  v_cvt_pk_bf16_f32 v37, v82, v83
  v_exp_f32 v86, v86
  v_exp_f32 v87, v87
  v_cvt_pk_bf16_f32 v38, v84, v85
  v_exp_f32 v88, v88
  v_exp_f32 v89, v89
  v_cvt_pk_bf16_f32 v39, v86, v87
  v_exp_f32 v90, v90
  v_exp_f32 v91, v91
  v_cvt_pk_bf16_f32 v40, v88, v89
  s_waitcnt lgkmcnt(2)
  v_mfma_f32_32x32x16_bf16 v[208:223], v[184:187], v[36:39], v[208:223]
  v_exp_f32 v92, v92
  v_exp_f32 v93, v93
  v_cvt_pk_bf16_f32 v41, v90, v91
  v_exp_f32 v94, v94
  v_exp_f32 v95, v95
  v_cvt_pk_bf16_f32 v42, v92, v93
  v_cvt_pk_bf16_f32 v43, v94, v95
  s_cmp_lt_u32 s8, 7
  s_cbranch_scc1 LB2_1_inv
  v_mfma_f32_32x32x16_bf16 v[80:95], v[132:135], v[60:63], v[12:27]
  s_branch LB2_1_done
LB2_1_inv:
  v_mfma_f32_32x32x16_bf16 v[80:95], v[132:135], v[60:63], v[192:207]
LB2_1_done:
  v_exp_f32 v64, v64
  v_exp_f32 v65, v65
  v_exp_f32 v66, v66
  v_exp_f32 v67, v67
  v_cvt_pk_bf16_f32 v28, v64, v65
  v_mfma_f32_32x32x16_bf16 v[208:223], v[188:191], v[40:43], v[208:223]
  s_mov_b64 exec, s[16:17]
  ds_read_b128 v[184:187], v7 offset:2048
  ds_read_b128 v[188:191], v7 offset:2560
  s_mov_b64 exec, -1
  v_exp_f32 v68, v68
  v_exp_f32 v69, v69
  v_cvt_pk_bf16_f32 v29, v66, v67
  v_exp_f32 v70, v70
  v_exp_f32 v71, v71
  v_cvt_pk_bf16_f32 v30, v68, v69
  v_exp_f32 v72, v72
  v_exp_f32 v73, v73
  v_cvt_pk_bf16_f32 v31, v70, v71
  v_exp_f32 v74, v74
  v_exp_f32 v75, v75
  v_cvt_pk_bf16_f32 v32, v72, v73
  s_waitcnt lgkmcnt(2)
  v_mfma_f32_32x32x16_bf16 v[208:223], v[176:179], v[28:31], v[208:223]
  v_exp_f32 v76, v76
  v_exp_f32 v77, v77
  v_cvt_pk_bf16_f32 v33, v74, v75
  v_exp_f32 v78, v78
  v_exp_f32 v79, v79
  v_cvt_pk_bf16_f32 v34, v76, v77
  v_cvt_pk_bf16_f32 v35, v78, v79
  s_cmp_lt_u32 s8, 8
  s_cbranch_scc1 LB2_0_inv
  v_mfma_f32_32x32x16_bf16 v[64:79], v[128:131], v[60:63], v[224:239]
  s_branch LB2_0_done
LB2_0_inv:
  v_mfma_f32_32x32x16_bf16 v[64:79], v[128:131], v[60:63], v[192:207]
LB2_0_done:
  v_exp_f32 v80, v80
  v_exp_f32 v81, v81
  v_exp_f32 v82, v82
  v_exp_f32 v83, v83
  v_cvt_pk_bf16_f32 v36, v80, v81
  v_mfma_f32_32x32x16_bf16 v[208:223], v[180:183], v[32:35], v[208:223]
  s_mov_b64 exec, s[16:17]
  ds_read_b128 v[176:179], v7 offset:0
  ds_read_b128 v[180:183], v7 offset:512
  s_mov_b64 exec, -1
  v_exp_f32 v84, v84
  v_exp_f32 v85, v85
  v_cvt_pk_bf16_f32 v37, v82, v83
  v_exp_f32 v86, v86
  v_exp_f32 v87, v87
  v_cvt_pk_bf16_f32 v38, v84, v85
  v_exp_f32 v88, v88
  v_exp_f32 v89, v89
  v_cvt_pk_bf16_f32 v39, v86, v87
  v_exp_f32 v90, v90
  v_exp_f32 v91, v91
  v_cvt_pk_bf16_f32 v40, v88, v89
  s_waitcnt lgkmcnt(2)
  v_mfma_f32_32x32x16_bf16 v[208:223], v[184:187], v[36:39], v[208:223]
  v_exp_f32 v92, v92
  v_exp_f32 v93, v93
  v_cvt_pk_bf16_f32 v41, v90, v91
  v_exp_f32 v94, v94
  v_exp_f32 v95, v95
  v_cvt_pk_bf16_f32 v42, v92, v93
  v_cvt_pk_bf16_f32 v43, v94, v95
  v_exp_f32 v64, v64
  v_exp_f32 v65, v65
  v_exp_f32 v66, v66
  v_exp_f32 v67, v67
  v_cvt_pk_bf16_f32 v28, v64, v65
  v_mfma_f32_32x32x16_bf16 v[208:223], v[188:191], v[40:43], v[208:223]
  v_exp_f32 v68, v68
  v_exp_f32 v69, v69
  v_cvt_pk_bf16_f32 v29, v66, v67
  v_exp_f32 v70, v70
  v_exp_f32 v71, v71
  v_cvt_pk_bf16_f32 v30, v68, v69
  v_exp_f32 v72, v72
  v_exp_f32 v73, v73
  v_cvt_pk_bf16_f32 v31, v70, v71
  v_exp_f32 v74, v74
  v_exp_f32 v75, v75
  v_cvt_pk_bf16_f32 v32, v72, v73
  s_waitcnt lgkmcnt(0)
  v_mfma_f32_32x32x16_bf16 v[208:223], v[176:179], v[28:31], v[208:223]
  v_exp_f32 v76, v76
  v_exp_f32 v77, v77
  v_cvt_pk_bf16_f32 v33, v74, v75
  v_exp_f32 v78, v78
  v_exp_f32 v79, v79
  v_cvt_pk_bf16_f32 v34, v76, v77
  v_cvt_pk_bf16_f32 v35, v78, v79
  s_nop 1
  v_mfma_f32_32x32x16_bf16 v[208:223], v[180:183], v[32:35], v[208:223]
  s_nop 15
  v_mov_b32 v28, v208
  v_mov_b32 v29, v209
  v_mov_b32 v30, v210
  v_mov_b32 v31, v211
  v_mov_b32 v32, v212
  v_mov_b32 v33, v213
  v_mov_b32 v34, v214
  v_mov_b32 v35, v215
  v_mov_b32 v36, v216
  s_branch B_DONE
K_CODE_END:
.section .rodata,"a"
.p2align 6
.amdhsa_kernel concat_heads__softmax_full_mha__sliding_block__prompt_kernel
  .amdhsa_next_free_vgpr 248
  .amdhsa_next_free_sgpr 102
  .amdhsa_accum_offset 248
  .amdhsa_group_segment_fixed_size 0
  .amdhsa_kernarg_size 72
  .amdhsa_user_sgpr_count 2
  .amdhsa_user_sgpr_kernarg_segment_ptr 1
  .amdhsa_system_sgpr_workgroup_id_x 1
.end_amdhsa_kernel
```
